```python
import torch

def _softmax(x, axis=-1):
    return torch.softmax(x, dim=axis)
def _gelu(x):
    return torch.nn.functional.gelu(x, approximate="tanh")
def _silu(x):
    return torch.nn.functional.silu(x)
def _sigmoid(x):
    return torch.sigmoid(x)
def _layernorm(x, axis=-1, eps=1e-5):
    m = x.mean(dim=axis, keepdim=True)
    v = x.var(dim=axis, keepdim=True, unbiased=False)
    return (x - m) / torch.sqrt(v + eps)
def _scatter_add(tgt, idx, src, axis=0):
    return tgt.clone().index_add_(axis, idx, src)
def _segment_sum(src, seg, n):
    out = torch.zeros((n,) + src.shape[1:], dtype=src.dtype)
    return out.index_add_(0, seg, src)
def _pad(x, pw):
    flat = tuple(v for pair in reversed(pw) for v in pair)
    return torch.nn.functional.pad(x, flat)

kernel_name = 'parallel_sum__ssm_conv_s4d__glu_gated_reglu__prompt'

def setup_inputs():

    _w = (lambda a: (lambda t: t.to(torch.bfloat16) if t.is_floating_point() else t)(torch.as_tensor(a)))
    def _A_setup():
        Bsz, L, D, N = 1, 2048, 448, 256
        return {
            "u": _w((lambda *s: torch.randn(*s, dtype=torch.bfloat16) * 0.05)(Bsz, L, D)),
            "log_A_real": _w((lambda *s: torch.randn(*s, dtype=torch.bfloat16) * 6.4)(D, N) * 0.5),
            "A_imag": _w((lambda *s: torch.randn(*s, dtype=torch.bfloat16) * 0.05)(D, N) * 3.14),
            "C_real": _w((lambda *s: torch.randn(*s, dtype=torch.bfloat16) * 0.1)(D, N) / N ** 0.5),
            "C_imag": _w((lambda *s: torch.randn(*s, dtype=torch.bfloat16) * 0.1)(D, N) / N ** 0.5),
            "log_dt": _w((lambda *s: torch.randn(*s, dtype=torch.bfloat16) * 0.05)(D) * 0.5 - 4.0),
            "D_skip": _w((lambda *s: torch.randn(*s, dtype=torch.bfloat16) * 0.05)(D)),
        }
    _A_in = _A_setup()

    def _B_setup():
        B, S, D, F = 1, 2048, 448, 1792
        return {
            "x": _w((lambda *s: torch.randn(*s, dtype=torch.bfloat16) * 0.05)(B, S, D)),
            "W_gate": _w((lambda *s: torch.randn(*s, dtype=torch.bfloat16) * 0.4)(D, F) * (2.0 / D) ** 0.5),
            "W_up": _w((lambda *s: torch.randn(*s, dtype=torch.bfloat16) * 0.4)(D, F) * (2.0 / D) ** 0.5),
            "W_down": _w((lambda *s: torch.randn(*s, dtype=torch.bfloat16) * 0.4)(F, D) * (1.0 / F) ** 0.5),
        }
    _B_in = _B_setup()

    return {
        "A_u": _A_in["u"],
        "A_log_A_real": _A_in["log_A_real"],
        "A_A_imag": _A_in["A_imag"],
        "A_C_real": _A_in["C_real"],
        "A_C_imag": _A_in["C_imag"],
        "A_log_dt": _A_in["log_dt"],
        "A_D_skip": _A_in["D_skip"],
        "B_x": _B_in["x"],
        "B_W_gate": _B_in["W_gate"],
        "B_W_up": _B_in["W_up"],
        "B_W_down": _B_in["W_down"],
    }

def reference(A_u, A_log_A_real, A_A_imag, A_C_real, A_C_imag, A_log_dt, A_D_skip, B_x, B_W_gate, B_W_up, B_W_down):
    def _A_ref(u, log_A_real, A_imag, C_real, C_imag, log_dt, D_skip):
        L = u.shape[1]
        dt = torch.exp(log_dt)
        A = -torch.exp(log_A_real) + 1j * A_imag
        C = (C_real + 1j * C_imag) * dt[:, None]
        pos = (lambda x, dt: x.to(dt))(torch.arange(L), log_dt.dtype)
        P = torch.exp((A * dt[:, None])[:, :, None] * pos[None, None, :])
        K = 2.0 * torch.einsum("dn,dnl->dl", C, P).real
        L2 = 2 * L
        u_t = (lambda x, *d: x.permute(*d))(u, 0, 2, 1)
        Kf = (lambda x, *a, **k: torch.fft.rfft(x.float(), *a, **k))(K, L2)
        Uf = (lambda x, *a, **k: torch.fft.rfft(x.float(), *a, **k))(u_t, L2)
        y = (lambda x, *a, **k: torch.fft.irfft(x, *a, **k).to(torch.bfloat16))(Uf * Kf[None, :, :], L2)[:, :, :L]
        y = (lambda x, *d: x.permute(*d))(y, 0, 2, 1)
        return y + u * D_skip[None, None, :]

    def _B_ref(x, W_gate, W_up, W_down):
        gate = torch.einsum("bsd,df->bsf", x, W_gate)
        up = torch.einsum("bsd,df->bsf", x, W_up)
        gate = gate * (lambda x, dt: x.to(dt))(gate > 0, gate.dtype)
        h = gate * up
        return torch.einsum("bsf,fd->bsd", h, W_down)

    x = A_u
    xn = _layernorm(x, axis=-1)
    return x + _A_ref(xn, A_log_A_real, A_A_imag, A_C_real, A_C_imag, A_log_dt, A_D_skip) + _B_ref(xn, B_W_gate, B_W_up, B_W_down)
```

```asm
; @launch grid=(256,1,1) block=(512,1,1) lds=163840
.amdgcn_target "amdgcn-amd-amdhsa--gfx950"
.text
.globl parallel_sum__ssm_conv_s4d__glu_gated_reglu__prompt_kernel
.p2align 8
.type parallel_sum__ssm_conv_s4d__glu_gated_reglu__prompt_kernel,@function
parallel_sum__ssm_conv_s4d__glu_gated_reglu__prompt_kernel:
    s_load_dwordx2 s[8:9], s[0:1], 64
    s_load_dwordx2 s[12:13], s[0:1], 72
    s_load_dwordx2 s[4:5], s[0:1], 0
    v_lshrrev_b32 v5, 6, v0
    v_and_b32 v1, 63, v0
    s_load_dwordx8 s[32:39], s[0:1], 8
    s_load_dwordx4 s[40:43], s[0:1], 40
    v_readfirstlane_b32 s60, v5
    s_load_dwordx2 s[16:17], s[0:1], 80
    s_load_dwordx2 s[24:25], s[0:1], 88
    s_load_dwordx2 s[28:29], s[0:1], 96
    s_load_dwordx2 s[20:21], s[0:1], 104
    s_memrealtime s[44:45]
    s_cmp_ge_u32 s2, 256
    s_cbranch_scc1 L_exit
    s_cmp_ge_u32 s60, 4
    s_cbranch_scc1 Lnp_1
    s_getpc_b64 s[76:77]
Lpc_2:
    s_sub_u32 s76, s76, Lpc_2-parallel_sum__ssm_conv_s4d__glu_gated_reglu__prompt_kernel
    s_subb_u32 s77, s77, 0
    v_lshlrev_b32 v254, 7, v0
    v_min_u32 v254, L_exit-parallel_sum__ssm_conv_s4d__glu_gated_reglu__prompt_kernel, v254
    global_load_dword v255, v254, s[76:77]
Lnp_1:
    s_mov_b32 s6, 1835008
    s_mov_b32 s7, 0x20000
    s_mov_b32 s10, 1605632
    s_mov_b32 s11, 0x20000
    s_and_b32 s70, s2, 7
    s_lshr_b32 s71, s2, 3
    s_cmp_lt_u32 s2, 32
    s_cbranch_scc1 L_helper
    s_sub_u32 s71, s71, 4
    s_and_b32 s73, s70, 1
    s_lshl_b32 s73, s73, 2
    s_lshr_b32 s74, s71, 3
    s_add_u32 s74, s74, s73
    s_and_b32 s61, s71, 7
    s_cmp_ge_u32 s71, 24
    s_cselect_b32 s62, 3, s74
    s_cselect_b32 s73, s73, 0
    s_add_u32 s61, s61, s73
    s_bfe_u32 s73, s70, 0x10001
    s_mul_i32 s73, s73, 7
    s_add_u32 s62, s62, s73
    s_lshr_b32 s73, s70, 2
    s_lshl3_add_u32 s61, s73, s61
    s_and_b32 s59, s60, 3
    s_lshl_b32 s58, s59, 12
    s_cmp_lt_u32 s60, 4
    s_cbranch_scc1 L_m
    v_lshrrev_b32 v7, 4, v1
    v_and_b32 v15, 15, v1
    v_lshlrev_b32 v14, 1, v7
    v_xor_b32 v14, v14, v15
    v_mul_u32_u24 v15, 3584, v7
    v_lshl_add_u32 v244, v14, 4, v15
    s_and_b32 s70, s59, 1
    s_mul_i32 s70, s70, 57344
    s_lshl_b32 s71, s62, 8
    s_add_u32 s56, s70, s71
    v_xor_b32 v14, 0x80, v244
    v_add_u32 v245, 13312, v244
    v_add_u32 v246, 26624, v14
    v_add_u32 v247, 39936, v14
    s_cmp_ge_u32 s59, 2
    s_waitcnt lgkmcnt(0)
    s_cselect_b32 s8, s12, s8
    s_cselect_b32 s9, s13, s9
    s_add_u32 m0, s58, 81920
    s_add_u32 s70, s56, 0
    buffer_load_dwordx4 v244, s[8:11], s70 offen offset:0 lds
    buffer_load_dwordx4 v245, s[8:11], s70 offen offset:1024 lds
    buffer_load_dwordx4 v246, s[8:11], s70 offen offset:2048 lds
    buffer_load_dwordx4 v247, s[8:11], s70 offen offset:3072 lds
    v_lshrrev_b32 v5, 3, v1
    v_and_b32 v6, 7, v1
    v_mul_u32_u24 v15, 896, v5
    v_xor_b32 v14, v7, v6
    v_lshl_add_u32 v240, v14, 4, v15
    s_lshl2_add_u32 s71, s61, s59
    s_mul_i32 s55, s71, 28672
    v_xor_b32 v14, 64, v240
    v_add_u32 v241, 6144, v14
    v_add_u32 v242, 12288, v240
    v_add_u32 v243, 18432, v14
    s_add_u32 m0, s58, 98304
    s_add_u32 s70, s55, 0
    buffer_load_dwordx4 v240, s[4:7], s70 offen offset:0 lds
    buffer_load_dwordx4 v241, s[4:7], s70 offen offset:1024 lds
    buffer_load_dwordx4 v242, s[4:7], s70 offen offset:2048 lds
    buffer_load_dwordx4 v243, s[4:7], s70 offen offset:3072 lds
    s_add_u32 m0, s58, 114688
    s_add_u32 s70, s56, 114688
    buffer_load_dwordx4 v244, s[8:11], s70 offen offset:0 lds
    buffer_load_dwordx4 v245, s[8:11], s70 offen offset:1024 lds
    buffer_load_dwordx4 v246, s[8:11], s70 offen offset:2048 lds
    buffer_load_dwordx4 v247, s[8:11], s70 offen offset:3072 lds
    s_mov_b64 s[18:19], s[10:11]
    s_mov_b64 s[26:27], s[6:7]
    s_mov_b32 s22, 0x10000000
    s_mov_b32 s23, s7
    s_movk_i32 s30, 256
    s_mov_b32 s31, s7
    s_and_b32 s73, s2, 7
    s_lshr_b32 s71, s2, 3
    s_sub_u32 s71, s71, 4
    s_mul_i32 s53, s71, 37
    s_lshr_b32 s53, s53, 8
    s_mul_i32 s72, s53, 7
    s_sub_u32 s64, s71, s72
    s_lshl2_add_u32 s63, s73, s53
    s_mul_i32 s65, s73, 28
    s_add_u32 s65, s65, s71
    v_lshrrev_b32 v5, 3, v1
    v_and_b32 v6, 7, v1
    v_lshrrev_b32 v7, 4, v1
    v_mul_u32_u24 v15, 896, v5
    v_lshlrev_b32 v14, 1, v7
    v_xor_b32 v14, v14, v6
    v_lshl_add_u32 v248, v14, 4, v15
    s_lshl_b32 s73, s65, 10
    s_lshl_b32 s74, s59, 8
    s_add_u32 s73, s73, s74
    v_lshl_add_u32 v19, v1, 1, s73
    s_lshl_b32 s69, s65, 2
    s_load_dword s78, s[40:41], s69
    s_load_dword s79, s[42:43], s69
    v_add_u32 v249, 6144, v248
    v_add_u32 v250, 12288, v248
    v_add_u32 v251, 18432, v248
    s_mul_i32 s57, s59, 401408
    s_lshl_b32 s71, s64, 7
    s_add_u32 s57, s57, s71
    s_lshr_b32 s48, s59, 1
    s_and_b32 s47, s59, 1
    s_lshl_b32 s46, s59, 8
    v_lshrrev_b32 v15, 5, v1
    v_lshlrev_b32 v15, 4, v15
    v_and_b32 v13, 31, v1
    v_cmp_eq_u32 vcc, 5, v13
    s_nop 1
    v_cndmask_b32_e64 v14, v13, 4, vcc
    v_cmp_eq_u32 vcc, 31, v13
    s_nop 1
    v_cndmask_b32_e64 v14, v14, 5, vcc
    v_and_b32 v16, 15, v14
    v_mul_u32_u24 v16, 2064, v16
    v_lshrrev_b32 v14, 4, v14
    v_lshl_add_u32 v16, v14, 10, v16
    v_add_u32 v16, v16, v15
    v_add_u32 v16, s46, v16
    v_add_u32 v14, -1, v13
    v_and_b32 v14, 31, v14
    v_and_b32 v17, 15, v14
    v_mul_u32_u24 v17, 2064, v17
    v_lshrrev_b32 v14, 4, v14
    v_lshl_add_u32 v17, v14, 10, v17
    v_add_u32 v17, v17, v15
    v_cmp_eq_u32 vcc, 0, v13
    v_mov_b32 v13, s46
    s_nop 0
    v_cndmask_b32_e64 v13, v13, 0, vcc
    v_add_u32 v17, v17, v13
    s_waitcnt lgkmcnt(0)
    s_lshr_b32 s72, s59, 1
    s_lshl_b32 s72, s72, 4
    s_lshr_b32 s78, s78, s72
    s_lshl_b32 s78, s78, 16
    s_lshr_b32 s79, s79, s72
    s_lshl_b32 s79, s79, 16
    v_mov_b32 v15, s78
    v_mul_f32 v12, 0x3fb8aa00, v15
    v_mul_f32 v15, 0x36eca570, v15
    v_exp_f32 v12, v12
    v_exp_f32 v15, v15
    s_nop 0
    v_mul_f32 v12, v12, v15
    v_cvt_pk_bf16_f32 v12, 0, v12
    s_add_u32 m0, s58, 131072
    s_add_u32 s70, s56, 229376
    buffer_load_dwordx4 v244, s[8:11], s70 offen offset:0 lds
    buffer_load_dwordx4 v245, s[8:11], s70 offen offset:1024 lds
    buffer_load_dwordx4 v246, s[8:11], s70 offen offset:2048 lds
    buffer_load_dwordx4 v247, s[8:11], s70 offen offset:3072 lds
    s_add_u32 m0, s58, 147456
    s_add_u32 s70, s55, 128
    buffer_load_dwordx4 v240, s[4:7], s70 offen offset:0 lds
    buffer_load_dwordx4 v241, s[4:7], s70 offen offset:1024 lds
    buffer_load_dwordx4 v242, s[4:7], s70 offen offset:2048 lds
    buffer_load_dwordx4 v243, s[4:7], s70 offen offset:3072 lds
    global_load_ushort v20, v19, s[32:33] offset:0
    global_load_ushort v21, v19, s[34:35] offset:0
    global_load_ushort v22, v19, s[36:37] offset:0
    global_load_ushort v23, v19, s[38:39] offset:0
    global_load_ushort v24, v19, s[32:33] offset:128
    global_load_ushort v25, v19, s[34:35] offset:128
    global_load_ushort v26, v19, s[36:37] offset:128
    global_load_ushort v27, v19, s[38:39] offset:128
    s_add_u32 s32, s53, 0
    s_cmp_ge_u32 s32, 4
    s_cselect_b32 s71, 4, 0
    s_sub_u32 s32, s32, s71
    s_add_u32 s33, s53, 1
    s_cmp_ge_u32 s33, 4
    s_cselect_b32 s71, 4, 0
    s_sub_u32 s33, s33, s71
    s_add_u32 s34, s53, 2
    s_cmp_ge_u32 s34, 4
    s_cselect_b32 s71, 4, 0
    s_sub_u32 s34, s34, s71
    s_add_u32 s35, s53, 3
    s_cmp_ge_u32 s35, 4
    s_cselect_b32 s71, 4, 0
    s_sub_u32 s35, s35, s71
    s_add_u32 s36, s53, 0
    s_cmp_ge_u32 s36, 3
    s_cselect_b32 s71, 3, 0
    s_sub_u32 s36, s36, s71
    s_add_u32 s36, s36, 4
    s_add_u32 s37, s53, 1
    s_cmp_ge_u32 s37, 3
    s_cselect_b32 s71, 3, 0
    s_sub_u32 s37, s37, s71
    s_add_u32 s37, s37, 4
    s_add_u32 s38, s53, 2
    s_cmp_ge_u32 s38, 3
    s_cselect_b32 s71, 3, 0
    s_sub_u32 s38, s38, s71
    s_add_u32 s38, s38, 4
    s_waitcnt vmcnt(20)
    s_barrier
    s_add_u32 m0, s58, 32768
    s_add_u32 s70, s56, 344064
    buffer_load_dwordx4 v244, s[8:11], s70 offen offset:0 lds
    buffer_load_dwordx4 v245, s[8:11], s70 offen offset:1024 lds
    buffer_load_dwordx4 v246, s[8:11], s70 offen offset:2048 lds
    buffer_load_dwordx4 v247, s[8:11], s70 offen offset:3072 lds
    s_add_u32 m0, s58, 49152
    s_add_u32 s70, s56, 458752
    buffer_load_dwordx4 v244, s[8:11], s70 offen offset:0 lds
    buffer_load_dwordx4 v245, s[8:11], s70 offen offset:1024 lds
    buffer_load_dwordx4 v246, s[8:11], s70 offen offset:2048 lds
    buffer_load_dwordx4 v247, s[8:11], s70 offen offset:3072 lds
    s_lshl_b32 s71, s59, 10
    s_add_u32 s71, s71, 15040512
    v_lshrrev_b32 v182, 3, v1
    v_lshl_add_u32 v182, v182, 7, s71
    v_lshrrev_b32 v184, 4, v1
    v_mul_u32_u24 v184, 57344, v184
    v_bfe_u32 v185, v1, 1, 3
    v_lshl_add_u32 v184, v185, 6, v184
    v_and_b32 v185, 1, v1
    v_lshl_add_u32 v184, v185, 4, v184
    v_mul_u32_u24 v185, 4608, v185
    v_lshrrev_b32 v186, 1, v1
    v_lshl_add_u32 v185, v186, 4, v185
    s_lshl_b32 s71, s59, 10
    s_add_u32 s71, s71, 17152
    v_add_u32 v185, s71, v185
    s_lshl1_add_u32 s74, s65, s48
    s_lshr_b32 s72, s65, 1
    s_lshl_b32 s72, s72, 9
    s_and_b32 s71, s65, 1
    s_lshl_b32 s71, s71, 5
    s_add_u32 s72, s72, s71
    s_mul_i32 s71, s59, 458752
    s_add_u32 s72, s72, s71
    s_add_u32 s72, s72, 8388608
    s_add_u32 s73, s72, 229376
    s_waitcnt vmcnt(24)
    s_barrier
    s_add_u32 m0, s58, 65536
    s_add_u32 s70, s55, 256
    buffer_load_dwordx4 v240, s[4:7], s70 offen offset:0 lds
    s_waitcnt vmcnt(9)
    v_and_b32 v28, 0x7fff, v22
    v_and_b32 v29, 0x7fff, v23
    buffer_load_dwordx4 v241, s[4:7], s70 offen offset:1024 lds
    v_and_b32 v30, 0x7fff, v26
    v_and_b32 v31, 0x7fff, v27
    v_max_u32 v28, v28, v29
    buffer_load_dwordx4 v242, s[4:7], s70 offen offset:2048 lds
    v_max3_u32 v28, v28, v30, v31
    v_lshlrev_b32 v20, 16, v20
    v_lshlrev_b32 v21, 16, v21
    buffer_load_dwordx4 v243, s[4:7], s70 offen offset:3072 lds
    v_max_u32_dpp v28, v28, v28 row_shr:1 row_mask:0xf bank_mask:0xf
    v_lshlrev_b32 v22, 16, v22
    v_lshlrev_b32 v23, 16, v23
    s_add_u32 m0, s58, 81920
    s_add_u32 s70, s56, 573440
    buffer_load_dwordx4 v244, s[8:11], s70 offen offset:0 lds
    v_max_u32_dpp v28, v28, v28 row_shr:2 row_mask:0xf bank_mask:0xf
    v_lshlrev_b32 v24, 16, v24
    v_lshlrev_b32 v25, 16, v25
    buffer_load_dwordx4 v245, s[8:11], s70 offen offset:1024 lds
    v_max_u32_dpp v28, v28, v28 row_shr:4 row_mask:0xf bank_mask:0xf
    v_lshlrev_b32 v26, 16, v26
    v_lshlrev_b32 v27, 16, v27
    buffer_load_dwordx4 v246, s[8:11], s70 offen offset:2048 lds
    v_max_u32_dpp v28, v28, v28 row_shr:8 row_mask:0xf bank_mask:0xf
    s_nop 1
    v_max_u32_dpp v28, v28, v28 row_bcast:15 row_mask:0xa bank_mask:0xf
    s_nop 1
    v_max_u32_dpp v28, v28, v28 row_bcast:31 row_mask:0xc bank_mask:0xf
    buffer_load_dwordx4 v247, s[8:11], s70 offen offset:3072 lds
    v_readlane_b32 s50, v28, 63
    s_nop 0
    s_lshr_b32 s50, s50, 7
    s_sub_u32 s50, 267, s50
    s_min_u32 s50, s50, 253
    s_sub_u32 s51, 255, s50
    s_lshl_b32 s50, s50, 23
    s_lshl_b32 s51, s51, 23
    v_mul_f32 v18, s51, v12
    v_mul_f32 v4, 0x3fb8aa3b, v20
    v_mul_f32 v5, v21, v12
    v_exp_f32 v4, v4
    s_barrier
    s_add_u32 m0, s58, 98304
    s_add_u32 s70, s56, 688128
    buffer_load_dwordx4 v244, s[8:11], s70 offen offset:0 lds
    v_mul_f32 v5, 0.15915494, v5
    v_mul_f32 v22, s50, v22
    v_cvt_pk_bf16_f32 v4, 0, v4
    v_mul_f32 v23, s50, v23
    buffer_load_dwordx4 v245, s[8:11], s70 offen offset:1024 lds
    v_mul_f32 v4, v4, v12
    v_cvt_pk_f16_f32 v76, v22, v23
    v_mul_f32 v4, 0xbfb8aa3b, v4
    v_mul_f32 v37, 0x41000000, v5
    buffer_load_dwordx4 v246, s[8:11], s70 offen offset:2048 lds
    v_mul_f32 v36, 0x41000000, v4
    v_mul_f32 v39, 0x42000000, v5
    v_mul_f32 v38, 0x42000000, v4
    v_mul_f32 v43, 0x43800000, v5
    buffer_load_dwordx4 v247, s[8:11], s70 offen offset:3072 lds
    v_mul_f32 v42, 0x43800000, v4
    v_fract_f32 v37, v37
    v_exp_f32 v36, v36
    v_fract_f32 v39, v39
    s_add_u32 m0, s58, 114688
    s_add_u32 s70, s55, 384
    buffer_load_dwordx4 v240, s[4:7], s70 offen offset:0 lds
    v_exp_f32 v38, v38
    v_fract_f32 v41, v5
    v_exp_f32 v40, v4
    v_fract_f32 v43, v43
    buffer_load_dwordx4 v241, s[4:7], s70 offen offset:1024 lds
    v_exp_f32 v42, v42
    v_cos_f32 v28, v37
    v_sin_f32 v29, v37
    v_cos_f32 v30, v39
    buffer_load_dwordx4 v242, s[4:7], s70 offen offset:2048 lds
    v_sin_f32 v31, v39
    v_cos_f32 v32, v41
    v_sin_f32 v33, v41
    v_cos_f32 v34, v43
    v_sin_f32 v35, v43
    v_mul_f32 v28, v28, v36
    v_mul_f32 v29, v29, v36
    v_mul_f32 v30, v30, v38
    s_waitcnt vmcnt(19)
    s_barrier
    s_add_u32 s70, s55, 384
    buffer_load_dwordx4 v243, s[4:7], s70 offen offset:3072 lds
    v_mul_f32 v31, v31, v38
    v_mul_f32 v32, v32, v40
    v_mul_f32 v33, v33, v40
    v_mul_f32 v34, v34, v42
    s_add_u32 m0, s58, 131072
    s_add_u32 s70, s56, 802816
    buffer_load_dwordx4 v244, s[8:11], s70 offen offset:0 lds
    v_mul_f32 v35, v35, v42
    v_cvt_pk_f16_f32 v45, v28, -v29
    v_cvt_pk_f16_f32 v7, v28, v29
    v_cvt_pk_f16_f32 v48, v30, -v31
    buffer_load_dwordx4 v245, s[8:11], s70 offen offset:1024 lds
    v_cvt_pk_f16_f32 v6, v32, v33
    v_cvt_pk_f16_f32 v8, v34, v35
    v_pk_mul_f16 v172, v45, v45 op_sel:[1,1] op_sel_hi:[0,1]
    v_pk_mul_f16 v173, v76, v7 op_sel:[1,1] op_sel_hi:[0,1]
    s_add_u32 m0, s58, 0
    s_mul_i32 s70, s32, 57344
    s_add_u32 s70, s70, s57
    buffer_load_dwordx4 v248, s[16:19], s70 offen offset:0 lds
    v_pk_fma_f16 v46, v45, v45, v172 op_sel_hi:[1,0,1] neg_lo:[0,0,1]
    v_pk_mul_f16 v174, v76, v6 op_sel:[1,1] op_sel_hi:[0,1]
    v_pk_fma_f16 v84, v76, v7, v173 op_sel_hi:[1,0,1] neg_lo:[0,0,1]
    v_pk_mul_f16 v175, v46, v45 op_sel:[1,1] op_sel_hi:[0,1]
    buffer_load_dwordx4 v249, s[16:19], s70 offen offset:1024 lds
    v_pk_fma_f16 v77, v76, v6, v174 op_sel_hi:[1,0,1] neg_lo:[0,0,1]
    v_pk_mul_f16 v176, v45, v48 op_sel:[1,1] op_sel_hi:[0,1]
    v_pk_fma_f16 v47, v46, v45, v175 op_sel_hi:[1,0,1] neg_lo:[0,0,1]
    v_pk_mul_f16 v177, v77, v6 op_sel:[1,1] op_sel_hi:[0,1]
    buffer_load_dwordx4 v250, s[16:19], s70 offen offset:2048 lds
    v_pk_fma_f16 v49, v45, v48, v176 op_sel_hi:[1,0,1] neg_lo:[0,0,1]
    v_pk_mul_f16 v178, v46, v48 op_sel:[1,1] op_sel_hi:[0,1]
    v_pk_fma_f16 v78, v77, v6, v177 op_sel_hi:[1,0,1] neg_lo:[0,0,1]
    v_pk_mul_f16 v179, v76, v8 op_sel:[1,1] op_sel_hi:[0,1]
    buffer_load_dwordx4 v251, s[16:19], s70 offen offset:3072 lds
    v_pk_fma_f16 v50, v46, v48, v178 op_sel_hi:[1,0,1] neg_lo:[0,0,1]
    v_pk_mul_f16 v172, v47, v48 op_sel:[1,1] op_sel_hi:[0,1]
    v_pk_fma_f16 v85, v76, v8, v179 op_sel_hi:[1,0,1] neg_lo:[0,0,1]
    v_pk_mul_f16 v173, v78, v6 op_sel:[1,1] op_sel_hi:[0,1]
    v_pk_fma_f16 v51, v47, v48, v172 op_sel_hi:[1,0,1] neg_lo:[0,0,1]
    v_pk_mul_f16 v174, v48, v48 op_sel:[1,1] op_sel_hi:[0,1]
    v_pk_fma_f16 v79, v78, v6, v173 op_sel_hi:[1,0,1] neg_lo:[0,0,1]
    v_pk_mul_f16 v175, v84, v8 op_sel:[1,1] op_sel_hi:[0,1]
    s_lshl_b32 s70, s59, 4
    s_lshl_b32 s71, s63, 6
    s_add_u32 s70, s70, s71
    v_lshrrev_b32 v235, 3, v1
    v_add_u32 v235, s70, v235
    v_mul_u32_u24 v234, 896, v235
    s_lshl_b32 s70, s64, 7
    s_movk_i32 s71, 7168
    v_and_b32 v230, 7, v1
    v_lshlrev_b32 v230, 4, v230
    v_add3_u32 v234, v234, v230, s70
    v_lshlrev_b32 v235, 3, v235
    v_add_u32 v235, 14811136, v235
    buffer_load_dwordx4 v[222:225], v234, s[4:7], 0 offen
    buffer_load_dwordx4 v[226:229], v234, s[4:7], s71 offen
    s_waitcnt vmcnt(20)
    s_barrier
    s_add_u32 m0, s58, 131072
    s_add_u32 s70, s56, 802816
    buffer_load_dwordx4 v246, s[8:11], s70 offen offset:2048 lds
    v_pk_fma_f16 v52, v48, v48, v174 op_sel_hi:[1,0,1] neg_lo:[0,0,1]
    v_pk_mul_f16 v176, v49, v48 op_sel:[1,1] op_sel_hi:[0,1]
    v_pk_fma_f16 v89, v84, v8, v175 op_sel_hi:[1,0,1] neg_lo:[0,0,1]
    v_pk_mul_f16 v177, v79, v6 op_sel:[1,1] op_sel_hi:[0,1]
    buffer_load_dwordx4 v247, s[8:11], s70 offen offset:3072 lds
    v_pk_fma_f16 v53, v49, v48, v176 op_sel_hi:[1,0,1] neg_lo:[0,0,1]
    v_pk_mul_f16 v178, v50, v48 op_sel:[1,1] op_sel_hi:[0,1]
    v_pk_fma_f16 v80, v79, v6, v177 op_sel_hi:[1,0,1] neg_lo:[0,0,1]
    v_pk_mul_f16 v179, v85, v8 op_sel:[1,1] op_sel_hi:[0,1]
    s_add_u32 m0, s58, 147456
    s_add_u32 s70, s56, 917504
    buffer_load_dwordx4 v244, s[8:11], s70 offen offset:0 lds
    v_pk_fma_f16 v54, v50, v48, v178 op_sel_hi:[1,0,1] neg_lo:[0,0,1]
    v_pk_mul_f16 v172, v51, v48 op_sel:[1,1] op_sel_hi:[0,1]
    v_pk_fma_f16 v90, v85, v8, v179 op_sel_hi:[1,0,1] neg_lo:[0,0,1]
    v_pk_mul_f16 v173, v80, v6 op_sel:[1,1] op_sel_hi:[0,1]
    buffer_load_dwordx4 v245, s[8:11], s70 offen offset:1024 lds
    v_pk_fma_f16 v55, v51, v48, v172 op_sel_hi:[1,0,1] neg_lo:[0,0,1]
    v_pk_mul_f16 v174, v52, v48 op_sel:[1,1] op_sel_hi:[0,1]
    v_pk_fma_f16 v81, v80, v6, v173 op_sel_hi:[1,0,1] neg_lo:[0,0,1]
    v_pk_mul_f16 v175, v89, v8 op_sel:[1,1] op_sel_hi:[0,1]
    buffer_load_dwordx4 v246, s[8:11], s70 offen offset:2048 lds
    v_pk_fma_f16 v56, v52, v48, v174 op_sel_hi:[1,0,1] neg_lo:[0,0,1]
    v_pk_mul_f16 v176, v53, v48 op_sel:[1,1] op_sel_hi:[0,1]
    v_pk_fma_f16 v92, v89, v8, v175 op_sel_hi:[1,0,1] neg_lo:[0,0,1]
    v_pk_mul_f16 v177, v81, v6 op_sel:[1,1] op_sel_hi:[0,1]
    buffer_load_dwordx4 v247, s[8:11], s70 offen offset:3072 lds
    v_pk_fma_f16 v57, v53, v48, v176 op_sel_hi:[1,0,1] neg_lo:[0,0,1]
    v_pk_mul_f16 v178, v54, v48 op_sel:[1,1] op_sel_hi:[0,1]
    v_pk_fma_f16 v82, v81, v6, v177 op_sel_hi:[1,0,1] neg_lo:[0,0,1]
    v_pk_mul_f16 v179, v90, v8 op_sel:[1,1] op_sel_hi:[0,1]
    s_add_u32 m0, s58, 32768
    s_add_u32 s70, s55, 512
    buffer_load_dwordx4 v240, s[4:7], s70 offen offset:0 lds
    v_pk_fma_f16 v58, v54, v48, v178 op_sel_hi:[1,0,1] neg_lo:[0,0,1]
    v_pk_mul_f16 v172, v55, v48 op_sel:[1,1] op_sel_hi:[0,1]
    v_pk_fma_f16 v93, v90, v8, v179 op_sel_hi:[1,0,1] neg_lo:[0,0,1]
    v_pk_mul_f16 v173, v82, v6 op_sel:[1,1] op_sel_hi:[0,1]
    v_pk_fma_f16 v59, v55, v48, v172 op_sel_hi:[1,0,1] neg_lo:[0,0,1]
    v_pk_mul_f16 v174, v56, v48 op_sel:[1,1] op_sel_hi:[0,1]
    v_pk_fma_f16 v83, v82, v6, v173 op_sel_hi:[1,0,1] neg_lo:[0,0,1]
    v_pk_mul_f16 v175, v92, v8 op_sel:[1,1] op_sel_hi:[0,1]
    buffer_load_dword v181, off, s[28:31], 0 sc1
    s_waitcnt vmcnt(24)
    s_barrier
    s_add_u32 s70, s55, 512
    buffer_load_dwordx4 v241, s[4:7], s70 offen offset:1024 lds
    v_pk_fma_f16 v60, v56, v48, v174 op_sel_hi:[1,0,1] neg_lo:[0,0,1]
    v_pk_mul_f16 v176, v57, v48 op_sel:[1,1] op_sel_hi:[0,1]
    v_pk_fma_f16 v95, v92, v8, v175 op_sel_hi:[1,0,1] neg_lo:[0,0,1]
    v_pk_mul_f16 v177, v78, v8 op_sel:[1,1] op_sel_hi:[0,1]
    buffer_load_dwordx4 v242, s[4:7], s70 offen offset:2048 lds
    v_pk_fma_f16 v61, v57, v48, v176 op_sel_hi:[1,0,1] neg_lo:[0,0,1]
    v_pk_mul_f16 v178, v58, v48 op_sel:[1,1] op_sel_hi:[0,1]
    v_pk_fma_f16 v86, v78, v8, v177 op_sel_hi:[1,0,1] neg_lo:[0,0,1]
    v_pk_mul_f16 v179, v93, v8 op_sel:[1,1] op_sel_hi:[0,1]
    buffer_load_dwordx4 v243, s[4:7], s70 offen offset:3072 lds
    v_pk_fma_f16 v62, v58, v48, v178 op_sel_hi:[1,0,1] neg_lo:[0,0,1]
    v_pk_mul_f16 v172, v59, v48 op_sel:[1,1] op_sel_hi:[0,1]
    v_pk_fma_f16 v96, v93, v8, v179 op_sel_hi:[1,0,1] neg_lo:[0,0,1]
    v_pk_mul_f16 v173, v80, v8 op_sel:[1,1] op_sel_hi:[0,1]
    s_add_u32 m0, s58, 16384
    s_mul_i32 s70, s32, 57344
    s_add_u32 s70, s70, s57
    s_add_u32 s70, s70, 28672
    buffer_load_dwordx4 v248, s[16:19], s70 offen offset:0 lds
    v_pk_fma_f16 v63, v59, v48, v172 op_sel_hi:[1,0,1] neg_lo:[0,0,1]
    v_pk_mul_f16 v174, v60, v48 op_sel:[1,1] op_sel_hi:[0,1]
    v_pk_fma_f16 v87, v80, v8, v173 op_sel_hi:[1,0,1] neg_lo:[0,0,1]
    v_pk_mul_f16 v175, v95, v8 op_sel:[1,1] op_sel_hi:[0,1]
    buffer_load_dwordx4 v249, s[16:19], s70 offen offset:1024 lds
    v_pk_fma_f16 v64, v60, v48, v174 op_sel_hi:[1,0,1] neg_lo:[0,0,1]
    v_pk_mul_f16 v176, v61, v48 op_sel:[1,1] op_sel_hi:[0,1]
    v_pk_fma_f16 v97, v95, v8, v175 op_sel_hi:[1,0,1] neg_lo:[0,0,1]
    v_pk_mul_f16 v177, v82, v8 op_sel:[1,1] op_sel_hi:[0,1]
    buffer_load_dwordx4 v250, s[16:19], s70 offen offset:2048 lds
    v_pk_fma_f16 v65, v61, v48, v176 op_sel_hi:[1,0,1] neg_lo:[0,0,1]
    v_pk_mul_f16 v178, v62, v48 op_sel:[1,1] op_sel_hi:[0,1]
    v_pk_fma_f16 v88, v82, v8, v177 op_sel_hi:[1,0,1] neg_lo:[0,0,1]
    v_pk_mul_f16 v179, v96, v8 op_sel:[1,1] op_sel_hi:[0,1]
    buffer_load_dwordx4 v251, s[16:19], s70 offen offset:3072 lds
    v_pk_fma_f16 v66, v62, v48, v178 op_sel_hi:[1,0,1] neg_lo:[0,0,1]
    v_pk_mul_f16 v172, v63, v48 op_sel:[1,1] op_sel_hi:[0,1]
    v_pk_fma_f16 v98, v96, v8, v179 op_sel_hi:[1,0,1] neg_lo:[0,0,1]
    v_pk_mul_f16 v173, v87, v8 op_sel:[1,1] op_sel_hi:[0,1]
    v_pk_fma_f16 v67, v63, v48, v172 op_sel_hi:[1,0,1] neg_lo:[0,0,1]
    v_pk_mul_f16 v174, v64, v48 op_sel:[1,1] op_sel_hi:[0,1]
    v_pk_fma_f16 v91, v87, v8, v173 op_sel_hi:[1,0,1] neg_lo:[0,0,1]
    v_pk_mul_f16 v175, v97, v8 op_sel:[1,1] op_sel_hi:[0,1]
    s_waitcnt vmcnt(23)
    s_barrier
    s_add_u32 m0, s58, 49152
    s_add_u32 s70, s56, 1032192
    buffer_load_dwordx4 v244, s[8:11], s70 offen offset:0 lds
    v_pk_fma_f16 v68, v64, v48, v174 op_sel_hi:[1,0,1] neg_lo:[0,0,1]
    v_pk_mul_f16 v176, v65, v48 op_sel:[1,1] op_sel_hi:[0,1]
    v_pk_fma_f16 v99, v97, v8, v175 op_sel_hi:[1,0,1] neg_lo:[0,0,1]
    v_pk_mul_f16 v177, v91, v8 op_sel:[1,1] op_sel_hi:[0,1]
    buffer_load_dwordx4 v245, s[8:11], s70 offen offset:1024 lds
    v_pk_fma_f16 v69, v65, v48, v176 op_sel_hi:[1,0,1] neg_lo:[0,0,1]
    v_pk_mul_f16 v178, v66, v48 op_sel:[1,1] op_sel_hi:[0,1]
    v_pk_fma_f16 v94, v91, v8, v177 op_sel_hi:[1,0,1] neg_lo:[0,0,1]
    v_pk_mul_f16 v179, v98, v8 op_sel:[1,1] op_sel_hi:[0,1]
    buffer_load_dwordx4 v246, s[8:11], s70 offen offset:2048 lds
    v_pk_fma_f16 v70, v66, v48, v178 op_sel_hi:[1,0,1] neg_lo:[0,0,1]
    v_pk_mul_f16 v172, v67, v48 op_sel:[1,1] op_sel_hi:[0,1]
    v_pk_fma_f16 v100, v98, v8, v179 op_sel_hi:[1,0,1] neg_lo:[0,0,1]
    v_pk_mul_f16 v173, v68, v48 op_sel:[1,1] op_sel_hi:[0,1]
    buffer_load_dwordx4 v247, s[8:11], s70 offen offset:3072 lds
    v_pk_fma_f16 v71, v67, v48, v172 op_sel_hi:[1,0,1] neg_lo:[0,0,1]
    v_pk_mul_f16 v174, v99, v8 op_sel:[1,1] op_sel_hi:[0,1]
    v_pk_fma_f16 v72, v68, v48, v173 op_sel_hi:[1,0,1] neg_lo:[0,0,1]
    v_pk_mul_f16 v175, v69, v48 op_sel:[1,1] op_sel_hi:[0,1]
    s_add_u32 m0, s58, 65536
    s_add_u32 s70, s56, 1146880
    buffer_load_dwordx4 v244, s[8:11], s70 offen offset:0 lds
    v_pk_fma_f16 v101, v99, v8, v174 op_sel_hi:[1,0,1] neg_lo:[0,0,1]
    v_pk_mul_f16 v176, v70, v48 op_sel:[1,1] op_sel_hi:[0,1]
    v_pk_fma_f16 v73, v69, v48, v175 op_sel_hi:[1,0,1] neg_lo:[0,0,1]
    v_pk_mul_f16 v177, v100, v8 op_sel:[1,1] op_sel_hi:[0,1]
    buffer_load_dwordx4 v245, s[8:11], s70 offen offset:1024 lds
    v_pk_fma_f16 v74, v70, v48, v176 op_sel_hi:[1,0,1] neg_lo:[0,0,1]
    v_pk_mul_f16 v178, v71, v48 op_sel:[1,1] op_sel_hi:[0,1]
    v_pk_fma_f16 v102, v100, v8, v177 op_sel_hi:[1,0,1] neg_lo:[0,0,1]
    v_pk_mul_f16 v179, v101, v8 op_sel:[1,1] op_sel_hi:[0,1]
    buffer_load_dwordx4 v246, s[8:11], s70 offen offset:2048 lds
    v_pk_fma_f16 v75, v71, v48, v178 op_sel_hi:[1,0,1] neg_lo:[0,0,1]
    v_pk_fma_f16 v103, v101, v8, v179 op_sel_hi:[1,0,1] neg_lo:[0,0,1]
    v_mul_f32 v4, 0x3fb8aa3b, v24
    v_mul_f32 v5, v25, v12
    v_exp_f32 v4, v4
    v_mul_f32 v5, 0.15915494, v5
    v_mul_f32 v26, s50, v26
    v_cvt_pk_bf16_f32 v4, 0, v4
    s_waitcnt vmcnt(20)
    s_barrier
    s_add_u32 s70, s56, 1146880
    buffer_load_dwordx4 v247, s[8:11], s70 offen offset:3072 lds
    v_mul_f32 v27, s50, v27
    v_mul_f32 v4, v4, v12
    v_cvt_pk_f16_f32 v140, v26, v27
    v_mul_f32 v4, 0xbfb8aa3b, v4
    s_add_u32 m0, s58, 81920
    s_add_u32 s70, s55, 640
    buffer_load_dwordx4 v240, s[4:7], s70 offen offset:0 lds
    v_mul_f32 v37, 0x41000000, v5
    v_mul_f32 v36, 0x41000000, v4
    v_mul_f32 v39, 0x42000000, v5
    v_mul_f32 v38, 0x42000000, v4
    buffer_load_dwordx4 v241, s[4:7], s70 offen offset:1024 lds
    v_mul_f32 v43, 0x43800000, v5
    v_mul_f32 v42, 0x43800000, v4
    v_fract_f32 v37, v37
    v_exp_f32 v36, v36
    buffer_load_dwordx4 v242, s[4:7], s70 offen offset:2048 lds
    v_fract_f32 v39, v39
    v_exp_f32 v38, v38
    v_fract_f32 v41, v5
    v_exp_f32 v40, v4
    buffer_load_dwordx4 v243, s[4:7], s70 offen offset:3072 lds
    v_fract_f32 v43, v43
    v_exp_f32 v42, v42
    v_cos_f32 v28, v37
    v_sin_f32 v29, v37
    s_add_u32 m0, s58, 98304
    s_add_u32 s70, s56, 1261568
    buffer_load_dwordx4 v244, s[8:11], s70 offen offset:0 lds
    v_cos_f32 v30, v39
    v_sin_f32 v31, v39
    v_cos_f32 v32, v41
    v_sin_f32 v33, v41
    buffer_load_dwordx4 v245, s[8:11], s70 offen offset:1024 lds
    v_cos_f32 v34, v43
    v_sin_f32 v35, v43
    v_mul_f32 v28, v28, v36
    v_mul_f32 v29, v29, v36
    v_mul_f32 v30, v30, v38
    v_mul_f32 v31, v31, v38
    v_mul_f32 v32, v32, v40
    v_mul_f32 v33, v33, v40
    s_cmp_lg_u32 s59, 0
    s_cbranch_scc1 Lfw_3
    s_lshl4_add_u32 s71, s61, s62
    s_lshl_b32 s71, s71, 7
    s_add_u32 s71, s71, 14876672
    v_mov_b32 v10, 0
    v_lshlrev_b32 v9, 2, v1
    s_mov_b32 exec_hi, 0
    buffer_store_dword v10, v9, s[20:23], s71 offen sc1
    s_mov_b32 exec_hi, -1
Lfw_3:
    s_waitcnt vmcnt(18)
    s_barrier
    s_add_u32 s70, s56, 1261568
    buffer_load_dwordx4 v246, s[8:11], s70 offen offset:2048 lds
    v_mul_f32 v34, v34, v42
    v_mul_f32 v35, v35, v42
    v_cvt_pk_f16_f32 v109, v28, -v29
    v_cvt_pk_f16_f32 v7, v28, v29
    buffer_load_dwordx4 v247, s[8:11], s70 offen offset:3072 lds
    v_cvt_pk_f16_f32 v112, v30, -v31
    v_cvt_pk_f16_f32 v6, v32, v33
    v_cvt_pk_f16_f32 v8, v34, v35
    v_pk_mul_f16 v172, v109, v109 op_sel:[1,1] op_sel_hi:[0,1]
    s_add_u32 m0, s58, 114688
    s_add_u32 s70, s56, 1376256
    buffer_load_dwordx4 v244, s[8:11], s70 offen offset:0 lds
    v_pk_mul_f16 v173, v140, v7 op_sel:[1,1] op_sel_hi:[0,1]
    v_pk_fma_f16 v110, v109, v109, v172 op_sel_hi:[1,0,1] neg_lo:[0,0,1]
    v_pk_mul_f16 v174, v140, v6 op_sel:[1,1] op_sel_hi:[0,1]
    v_pk_fma_f16 v148, v140, v7, v173 op_sel_hi:[1,0,1] neg_lo:[0,0,1]
    buffer_load_dwordx4 v245, s[8:11], s70 offen offset:1024 lds
    v_pk_mul_f16 v175, v110, v109 op_sel:[1,1] op_sel_hi:[0,1]
    v_pk_fma_f16 v141, v140, v6, v174 op_sel_hi:[1,0,1] neg_lo:[0,0,1]
    v_pk_mul_f16 v176, v109, v112 op_sel:[1,1] op_sel_hi:[0,1]
    v_pk_fma_f16 v111, v110, v109, v175 op_sel_hi:[1,0,1] neg_lo:[0,0,1]
    buffer_load_dwordx4 v246, s[8:11], s70 offen offset:2048 lds
    v_pk_mul_f16 v177, v141, v6 op_sel:[1,1] op_sel_hi:[0,1]
    v_pk_fma_f16 v113, v109, v112, v176 op_sel_hi:[1,0,1] neg_lo:[0,0,1]
    v_pk_mul_f16 v178, v110, v112 op_sel:[1,1] op_sel_hi:[0,1]
    v_pk_fma_f16 v142, v141, v6, v177 op_sel_hi:[1,0,1] neg_lo:[0,0,1]
    buffer_load_dwordx4 v247, s[8:11], s70 offen offset:3072 lds
    v_pk_mul_f16 v179, v140, v8 op_sel:[1,1] op_sel_hi:[0,1]
    v_pk_fma_f16 v114, v110, v112, v178 op_sel_hi:[1,0,1] neg_lo:[0,0,1]
    v_pk_mul_f16 v172, v111, v112 op_sel:[1,1] op_sel_hi:[0,1]
    v_pk_fma_f16 v149, v140, v8, v179 op_sel_hi:[1,0,1] neg_lo:[0,0,1]
    s_add_u32 m0, s58, 131072
    s_add_u32 s70, s55, 768
    buffer_load_dwordx4 v240, s[4:7], s70 offen offset:0 lds
    v_pk_mul_f16 v173, v142, v6 op_sel:[1,1] op_sel_hi:[0,1]
    v_pk_fma_f16 v115, v111, v112, v172 op_sel_hi:[1,0,1] neg_lo:[0,0,1]
    v_pk_mul_f16 v174, v112, v112 op_sel:[1,1] op_sel_hi:[0,1]
    v_pk_fma_f16 v143, v142, v6, v173 op_sel_hi:[1,0,1] neg_lo:[0,0,1]
    v_pk_mul_f16 v175, v148, v8 op_sel:[1,1] op_sel_hi:[0,1]
    v_pk_fma_f16 v116, v112, v112, v174 op_sel_hi:[1,0,1] neg_lo:[0,0,1]
    v_pk_mul_f16 v176, v113, v112 op_sel:[1,1] op_sel_hi:[0,1]
    v_pk_fma_f16 v153, v148, v8, v175 op_sel_hi:[1,0,1] neg_lo:[0,0,1]
    s_waitcnt vmcnt(17)
    s_barrier
    s_add_u32 s70, s55, 768
    buffer_load_dwordx4 v241, s[4:7], s70 offen offset:1024 lds
    v_pk_mul_f16 v177, v143, v6 op_sel:[1,1] op_sel_hi:[0,1]
    v_pk_fma_f16 v117, v113, v112, v176 op_sel_hi:[1,0,1] neg_lo:[0,0,1]
    v_pk_mul_f16 v178, v114, v112 op_sel:[1,1] op_sel_hi:[0,1]
    v_pk_fma_f16 v144, v143, v6, v177 op_sel_hi:[1,0,1] neg_lo:[0,0,1]
    buffer_load_dwordx4 v242, s[4:7], s70 offen offset:2048 lds
    v_pk_mul_f16 v179, v149, v8 op_sel:[1,1] op_sel_hi:[0,1]
    v_pk_fma_f16 v118, v114, v112, v178 op_sel_hi:[1,0,1] neg_lo:[0,0,1]
    v_pk_mul_f16 v172, v115, v112 op_sel:[1,1] op_sel_hi:[0,1]
    v_pk_fma_f16 v154, v149, v8, v179 op_sel_hi:[1,0,1] neg_lo:[0,0,1]
    buffer_load_dwordx4 v243, s[4:7], s70 offen offset:3072 lds
    v_pk_mul_f16 v173, v144, v6 op_sel:[1,1] op_sel_hi:[0,1]
    v_pk_fma_f16 v119, v115, v112, v172 op_sel_hi:[1,0,1] neg_lo:[0,0,1]
    v_pk_mul_f16 v174, v116, v112 op_sel:[1,1] op_sel_hi:[0,1]
    v_pk_fma_f16 v145, v144, v6, v173 op_sel_hi:[1,0,1] neg_lo:[0,0,1]
    s_add_u32 m0, s58, 147456
    s_add_u32 s70, s56, 1490944
    buffer_load_dwordx4 v244, s[8:11], s70 offen offset:0 lds
    v_pk_mul_f16 v175, v153, v8 op_sel:[1,1] op_sel_hi:[0,1]
    v_pk_fma_f16 v120, v116, v112, v174 op_sel_hi:[1,0,1] neg_lo:[0,0,1]
    v_pk_mul_f16 v176, v117, v112 op_sel:[1,1] op_sel_hi:[0,1]
    v_pk_fma_f16 v156, v153, v8, v175 op_sel_hi:[1,0,1] neg_lo:[0,0,1]
    buffer_load_dwordx4 v245, s[8:11], s70 offen offset:1024 lds
    v_pk_mul_f16 v177, v145, v6 op_sel:[1,1] op_sel_hi:[0,1]
    v_pk_fma_f16 v121, v117, v112, v176 op_sel_hi:[1,0,1] neg_lo:[0,0,1]
    v_pk_mul_f16 v178, v118, v112 op_sel:[1,1] op_sel_hi:[0,1]
    v_pk_fma_f16 v146, v145, v6, v177 op_sel_hi:[1,0,1] neg_lo:[0,0,1]
    buffer_load_dwordx4 v246, s[8:11], s70 offen offset:2048 lds
    v_pk_mul_f16 v179, v154, v8 op_sel:[1,1] op_sel_hi:[0,1]
    v_pk_fma_f16 v122, v118, v112, v178 op_sel_hi:[1,0,1] neg_lo:[0,0,1]
    v_pk_mul_f16 v172, v119, v112 op_sel:[1,1] op_sel_hi:[0,1]
    v_pk_fma_f16 v157, v154, v8, v179 op_sel_hi:[1,0,1] neg_lo:[0,0,1]
    buffer_load_dwordx4 v247, s[8:11], s70 offen offset:3072 lds
    v_pk_mul_f16 v173, v146, v6 op_sel:[1,1] op_sel_hi:[0,1]
    v_pk_fma_f16 v123, v119, v112, v172 op_sel_hi:[1,0,1] neg_lo:[0,0,1]
    v_pk_mul_f16 v174, v120, v112 op_sel:[1,1] op_sel_hi:[0,1]
    v_pk_fma_f16 v147, v146, v6, v173 op_sel_hi:[1,0,1] neg_lo:[0,0,1]
    v_pk_mul_f16 v175, v156, v8 op_sel:[1,1] op_sel_hi:[0,1]
    v_pk_fma_f16 v124, v120, v112, v174 op_sel_hi:[1,0,1] neg_lo:[0,0,1]
    v_pk_mul_f16 v176, v121, v112 op_sel:[1,1] op_sel_hi:[0,1]
    v_pk_fma_f16 v159, v156, v8, v175 op_sel_hi:[1,0,1] neg_lo:[0,0,1]
    s_movk_i32 s77, 600
    v_readfirstlane_b32 s67, v181
    s_nop 0
    s_sub_u32 s76, s44, s67
    s_cmp_lt_i32 s76, s77
    s_cselect_b32 s76, s67, 0
    s_cmp_lg_u32 s76, 0
    s_cbranch_scc1 Lnok_5
    s_mov_b32 s68, 200000
Lnon_4:
    buffer_load_dword v181, off, s[28:31], 0 sc1
    s_waitcnt vmcnt(0)
    v_readfirstlane_b32 s67, v181
    s_nop 0
    s_sub_u32 s76, s44, s67
    s_cmp_lt_i32 s76, s77
    s_cselect_b32 s76, s67, 0
    s_cmp_lg_u32 s76, 0
    s_cbranch_scc1 Lnok_5
    s_sub_u32 s68, s68, 1
    s_cmp_lt_u32 s68, 199900
    s_cselect_b32 s77, 0x7fffffff, s77
    s_cmp_lg_u32 s68, 0
    s_cbranch_scc1 Lnon_4
Lnok_5:
    s_waitcnt vmcnt(16)
    s_barrier
    s_add_u32 m0, s58, 32768
    s_mul_i32 s70, s33, 57344
    s_add_u32 s70, s70, s57
    buffer_load_dwordx4 v248, s[16:19], s70 offen offset:0 lds
    v_pk_mul_f16 v177, v142, v8 op_sel:[1,1] op_sel_hi:[0,1]
    v_pk_fma_f16 v125, v121, v112, v176 op_sel_hi:[1,0,1] neg_lo:[0,0,1]
    v_pk_mul_f16 v178, v122, v112 op_sel:[1,1] op_sel_hi:[0,1]
    v_pk_fma_f16 v150, v142, v8, v177 op_sel_hi:[1,0,1] neg_lo:[0,0,1]
    v_pk_mul_f16 v179, v157, v8 op_sel:[1,1] op_sel_hi:[0,1]
    v_pk_fma_f16 v126, v122, v112, v178 op_sel_hi:[1,0,1] neg_lo:[0,0,1]
    buffer_load_dwordx4 v249, s[16:19], s70 offen offset:1024 lds
    v_pk_mul_f16 v172, v123, v112 op_sel:[1,1] op_sel_hi:[0,1]
    v_pk_fma_f16 v160, v157, v8, v179 op_sel_hi:[1,0,1] neg_lo:[0,0,1]
    v_pk_mul_f16 v173, v144, v8 op_sel:[1,1] op_sel_hi:[0,1]
    v_pk_fma_f16 v127, v123, v112, v172 op_sel_hi:[1,0,1] neg_lo:[0,0,1]
    v_pk_mul_f16 v174, v124, v112 op_sel:[1,1] op_sel_hi:[0,1]
    v_pk_fma_f16 v151, v144, v8, v173 op_sel_hi:[1,0,1] neg_lo:[0,0,1]
    buffer_load_dwordx4 v250, s[16:19], s70 offen offset:2048 lds
    v_pk_mul_f16 v175, v159, v8 op_sel:[1,1] op_sel_hi:[0,1]
    v_pk_fma_f16 v128, v124, v112, v174 op_sel_hi:[1,0,1] neg_lo:[0,0,1]
    v_pk_mul_f16 v176, v125, v112 op_sel:[1,1] op_sel_hi:[0,1]
    v_pk_fma_f16 v161, v159, v8, v175 op_sel_hi:[1,0,1] neg_lo:[0,0,1]
    v_pk_mul_f16 v177, v146, v8 op_sel:[1,1] op_sel_hi:[0,1]
    v_pk_fma_f16 v129, v125, v112, v176 op_sel_hi:[1,0,1] neg_lo:[0,0,1]
    buffer_load_dwordx4 v251, s[16:19], s70 offen offset:3072 lds
    v_pk_mul_f16 v178, v126, v112 op_sel:[1,1] op_sel_hi:[0,1]
    v_pk_fma_f16 v152, v146, v8, v177 op_sel_hi:[1,0,1] neg_lo:[0,0,1]
    v_pk_mul_f16 v179, v160, v8 op_sel:[1,1] op_sel_hi:[0,1]
    v_pk_fma_f16 v130, v126, v112, v178 op_sel_hi:[1,0,1] neg_lo:[0,0,1]
    v_pk_mul_f16 v172, v127, v112 op_sel:[1,1] op_sel_hi:[0,1]
    v_pk_fma_f16 v162, v160, v8, v179 op_sel_hi:[1,0,1] neg_lo:[0,0,1]
    v_pk_mul_f16 v173, v151, v8 op_sel:[1,1] op_sel_hi:[0,1]
    v_pk_fma_f16 v131, v127, v112, v172 op_sel_hi:[1,0,1] neg_lo:[0,0,1]
    v_pk_mul_f16 v174, v128, v112 op_sel:[1,1] op_sel_hi:[0,1]
    v_pk_fma_f16 v155, v151, v8, v173 op_sel_hi:[1,0,1] neg_lo:[0,0,1]
    v_pk_mul_f16 v175, v161, v8 op_sel:[1,1] op_sel_hi:[0,1]
    v_pk_fma_f16 v132, v128, v112, v174 op_sel_hi:[1,0,1] neg_lo:[0,0,1]
    v_pk_mul_f16 v176, v129, v112 op_sel:[1,1] op_sel_hi:[0,1]
    v_pk_fma_f16 v163, v161, v8, v175 op_sel_hi:[1,0,1] neg_lo:[0,0,1]
    s_waitcnt vmcnt(4)
    s_barrier
    buffer_load_dword v183, v182, s[20:23], 0 offen sc1
    s_add_u32 m0, s58, 49152
    s_mul_i32 s70, s33, 57344
    s_add_u32 s70, s70, s57
    s_add_u32 s70, s70, 28672
    buffer_load_dwordx4 v248, s[16:19], s70 offen offset:0 lds
    buffer_load_dwordx4 v249, s[16:19], s70 offen offset:1024 lds
    buffer_load_dwordx4 v250, s[16:19], s70 offen offset:2048 lds
    buffer_load_dwordx4 v251, s[16:19], s70 offen offset:3072 lds
    v_pk_mul_f16 v177, v155, v8 op_sel:[1,1] op_sel_hi:[0,1]
    v_pk_fma_f16 v133, v129, v112, v176 op_sel_hi:[1,0,1] neg_lo:[0,0,1]
    v_pk_mul_f16 v178, v130, v112 op_sel:[1,1] op_sel_hi:[0,1]
    v_pk_fma_f16 v158, v155, v8, v177 op_sel_hi:[1,0,1] neg_lo:[0,0,1]
    v_pk_mul_f16 v179, v162, v8 op_sel:[1,1] op_sel_hi:[0,1]
    v_pk_fma_f16 v134, v130, v112, v178 op_sel_hi:[1,0,1] neg_lo:[0,0,1]
    v_pk_mul_f16 v172, v131, v112 op_sel:[1,1] op_sel_hi:[0,1]
    v_pk_fma_f16 v164, v162, v8, v179 op_sel_hi:[1,0,1] neg_lo:[0,0,1]
    v_pk_mul_f16 v173, v132, v112 op_sel:[1,1] op_sel_hi:[0,1]
    v_pk_fma_f16 v135, v131, v112, v172 op_sel_hi:[1,0,1] neg_lo:[0,0,1]
    v_pk_mul_f16 v174, v163, v8 op_sel:[1,1] op_sel_hi:[0,1]
    v_pk_fma_f16 v136, v132, v112, v173 op_sel_hi:[1,0,1] neg_lo:[0,0,1]
    v_pk_mul_f16 v175, v133, v112 op_sel:[1,1] op_sel_hi:[0,1]
    v_pk_fma_f16 v165, v163, v8, v174 op_sel_hi:[1,0,1] neg_lo:[0,0,1]
    v_pk_mul_f16 v176, v134, v112 op_sel:[1,1] op_sel_hi:[0,1]
    v_pk_fma_f16 v137, v133, v112, v175 op_sel_hi:[1,0,1] neg_lo:[0,0,1]
    v_pk_mul_f16 v177, v164, v8 op_sel:[1,1] op_sel_hi:[0,1]
    v_pk_fma_f16 v138, v134, v112, v176 op_sel_hi:[1,0,1] neg_lo:[0,0,1]
    v_pk_mul_f16 v178, v135, v112 op_sel:[1,1] op_sel_hi:[0,1]
    v_pk_fma_f16 v166, v164, v8, v177 op_sel_hi:[1,0,1] neg_lo:[0,0,1]
    v_pk_mul_f16 v179, v165, v8 op_sel:[1,1] op_sel_hi:[0,1]
    v_pk_fma_f16 v139, v135, v112, v178 op_sel_hi:[1,0,1] neg_lo:[0,0,1]
    v_pk_fma_f16 v167, v165, v8, v179 op_sel_hi:[1,0,1] neg_lo:[0,0,1]
    v_and_b32 v9, 15, v1
    v_lshrrev_b32 v10, 4, v1
    v_lshlrev_b32 v11, 3, v10
    v_sub_u32 v11, v9, v11
    s_mul_i32 s39, s48, 8320
    s_lshl_b32 s40, s47, 9
    s_add_u32 s39, s39, s40
    s_add_u32 s39, s39, 100
    v_lshl_add_u32 v172, v11, 2, s39
    v_add_u32 v173, 1024, v172
    v_add_u32 v174, 2048, v172
    v_add_u32 v175, 3072, v172
    v_add_u32 v176, 4096, v172
    v_add_u32 v177, 5120, v172
    v_add_u32 v178, 6144, v172
    v_add_u32 v179, 7168, v172
    s_mul_i32 s39, s48, 4608
    s_lshl_b32 s40, s47, 8
    s_sub_u32 s39, s39, s40
    s_add_u32 s39, s39, 16928
    v_lshlrev_b32 v11, 5, v9
    v_lshl_add_u32 v11, v10, 4, v11
    v_add_u32 v180, s39, v11
    s_waitcnt vmcnt(8)
    s_mul_i32 s70, s38, 57344
    s_add_u32 s70, s70, s57
    buffer_load_dwordx4 v[200:203], v248, s[16:19], s70 offen offset:0
    buffer_load_dwordx4 v[204:207], v249, s[16:19], s70 offen offset:1024
    buffer_load_dwordx4 v[208:211], v250, s[16:19], s70 offen offset:2048
    buffer_load_dwordx4 v[212:215], v251, s[16:19], s70 offen offset:3072
    s_waitcnt vmcnt(8)
    s_mul_i32 s70, s38, 57344
    s_add_u32 s70, s70, s57
    s_add_u32 s70, s70, 28672
    buffer_load_dwordx4 v[216:219], v248, s[16:19], s70 offen offset:0
    buffer_load_dwordx4 v[236:239], v249, s[16:19], s70 offen offset:1024
    buffer_load_dwordx4 v[188:191], v250, s[16:19], s70 offen offset:2048
    buffer_load_dwordx4 v[252:255], v251, s[16:19], s70 offen offset:3072
    v_cmp_ne_u32 vcc, s67, v183
    s_nop 4
    s_cbranch_vccz Lok_8
    s_mov_b32 s68, 200000
Lspin_7:
    buffer_load_dword v183, v182, s[20:23], 0 offen sc1
    s_waitcnt vmcnt(0)
    v_cmp_ne_u32 vcc, s67, v183
    s_nop 4
    s_cbranch_vccz Lok_8
    s_sleep 2
    s_sub_u32 s68, s68, 1
    s_cmp_lg_u32 s68, 0
    s_cbranch_scc1 Lspin_7
Lok_8:
    buffer_load_dwordx4 v[192:195], v184, s[20:23], s72 offen sc1
    buffer_load_dwordx4 v[196:199], v184, s[20:23], s73 offen sc1
    buffer_load_dwordx2 v[230:231], v235, s[20:23], 0 offen offset:0 sc1
    buffer_load_dwordx2 v[232:233], v235, s[20:23], 0 offen offset:64 sc1
    s_setprio 1
    v_lshlrev_b32 v13, 2, v1
    v_mov_b32 v14, 0x3c00
    ds_write_b32 v13, v14 offset:31984
    s_mov_b32 m0, s46
    s_nop 0
    ds_write_addtid_b32 v45 offset:0
    ds_write_addtid_b32 v46 offset:2064
    ds_write_addtid_b32 v47 offset:4128
    ds_write_addtid_b32 v48 offset:6192
    ds_write_addtid_b32 v49 offset:8256
    ds_write_addtid_b32 v50 offset:10320
    ds_write_addtid_b32 v51 offset:12384
    ds_write_addtid_b32 v52 offset:14448
    ds_write_addtid_b32 v53 offset:16512
    ds_write_addtid_b32 v54 offset:18576
    ds_write_addtid_b32 v55 offset:20640
    ds_write_addtid_b32 v56 offset:22704
    ds_write_addtid_b32 v57 offset:24768
    ds_write_addtid_b32 v58 offset:26832
    ds_write_addtid_b32 v59 offset:28896
    ds_write_addtid_b32 v60 offset:30960
    ds_write_addtid_b32 v61 offset:1024
    ds_write_addtid_b32 v62 offset:3088
    ds_write_addtid_b32 v63 offset:5152
    ds_write_addtid_b32 v64 offset:7216
    ds_write_addtid_b32 v65 offset:9280
    ds_write_addtid_b32 v66 offset:11344
    ds_write_addtid_b32 v67 offset:13408
    ds_write_addtid_b32 v68 offset:15472
    ds_write_addtid_b32 v69 offset:17536
    ds_write_addtid_b32 v70 offset:19600
    ds_write_addtid_b32 v71 offset:21664
    ds_write_addtid_b32 v72 offset:23728
    ds_write_addtid_b32 v73 offset:25792
    ds_write_addtid_b32 v74 offset:27856
    ds_write_addtid_b32 v75 offset:29920
    ds_read_b128 v[44:47], v17 offset:0
    ds_read_b128 v[48:51], v17 offset:32
    ds_read_b128 v[52:55], v17 offset:64
    ds_read_b128 v[56:59], v17 offset:96
    ds_read_b128 v[60:63], v17 offset:128
    ds_read_b128 v[64:67], v17 offset:160
    ds_read_b128 v[68:71], v17 offset:192
    ds_read_b128 v[72:75], v17 offset:224
    ds_write_addtid_b32 v76 offset:0
    ds_write_addtid_b32 v77 offset:2064
    ds_write_addtid_b32 v78 offset:4128
    ds_write_addtid_b32 v79 offset:6192
    ds_write_addtid_b32 v80 offset:16512
    ds_write_addtid_b32 v81 offset:18576
    ds_write_addtid_b32 v82 offset:20640
    ds_write_addtid_b32 v83 offset:22704
    ds_write_addtid_b32 v84 offset:1024
    ds_write_addtid_b32 v85 offset:8256
    ds_write_addtid_b32 v86 offset:12384
    ds_write_addtid_b32 v87 offset:14448
    ds_write_addtid_b32 v87 offset:24768
    ds_write_addtid_b32 v87 offset:26832
    ds_write_addtid_b32 v88 offset:28896
    ds_write_addtid_b32 v89 offset:30960
    ds_write_addtid_b32 v89 offset:9280
    ds_write_addtid_b32 v90 offset:3088
    ds_write_addtid_b32 v91 offset:5152
    ds_write_addtid_b32 v92 offset:7216
    ds_write_addtid_b32 v93 offset:11344
    ds_write_addtid_b32 v94 offset:13408
    ds_write_addtid_b32 v95 offset:15472
    ds_write_addtid_b32 v96 offset:17536
    ds_write_addtid_b32 v97 offset:19600
    ds_write_addtid_b32 v98 offset:25792
    ds_write_addtid_b32 v99 offset:27856
    ds_write_addtid_b32 v100 offset:21664
    ds_write_addtid_b32 v101 offset:23728
    ds_write_addtid_b32 v102 offset:29920
    ds_write_addtid_b32 v103 offset:10320
    ds_read_b128 v[76:79], v16 offset:0
    ds_read_b128 v[80:83], v16 offset:32
    ds_read_b128 v[84:87], v16 offset:64
    ds_read_b128 v[88:91], v16 offset:96
    ds_read_b128 v[92:95], v16 offset:128
    ds_read_b128 v[96:99], v16 offset:160
    ds_read_b128 v[100:103], v16 offset:192
    ds_read_b128 v[104:107], v16 offset:224
    s_waitcnt vmcnt(12)
    s_lshl_b32 s70, s59, 2
    v_mov_b32 v13, s70
    v_mov_b32 v14, s67
    ds_write_b32 v13, v14 offset:32256
    v_and_b32 v13, 3, v1
    v_lshlrev_b32 v13, 2, v13
    ds_write_addtid_b32 v109 offset:0
    ds_write_addtid_b32 v110 offset:2064
    ds_write_addtid_b32 v111 offset:4128
    ds_write_addtid_b32 v112 offset:6192
    ds_write_addtid_b32 v113 offset:8256
    ds_write_addtid_b32 v114 offset:10320
    ds_write_addtid_b32 v115 offset:12384
    ds_write_addtid_b32 v116 offset:14448
    ds_write_addtid_b32 v117 offset:16512
    ds_write_addtid_b32 v118 offset:18576
    ds_write_addtid_b32 v119 offset:20640
    ds_write_addtid_b32 v120 offset:22704
    ds_write_addtid_b32 v121 offset:24768
    ds_write_addtid_b32 v122 offset:26832
    ds_write_addtid_b32 v123 offset:28896
    s_waitcnt lgkmcnt(15)
    v_mfma_f32_32x32x16_f16 v[28:43], v[76:79], v[44:47], 0
    ds_write_addtid_b32 v124 offset:30960
    ds_write_addtid_b32 v125 offset:1024
    ds_write_addtid_b32 v126 offset:3088
    ds_write_addtid_b32 v127 offset:5152
    v_mfma_f32_32x32x16_f16 v[28:43], v[80:83], v[48:51], v[28:43]
    ds_write_addtid_b32 v128 offset:7216
    ds_write_addtid_b32 v129 offset:9280
    ds_write_addtid_b32 v130 offset:11344
    ds_write_addtid_b32 v131 offset:13408
    v_mfma_f32_32x32x16_f16 v[28:43], v[84:87], v[52:55], v[28:43]
    ds_write_addtid_b32 v132 offset:15472
    ds_write_addtid_b32 v133 offset:17536
    ds_write_addtid_b32 v134 offset:19600
    ds_write_addtid_b32 v135 offset:21664
    v_mfma_f32_32x32x16_f16 v[28:43], v[88:91], v[56:59], v[28:43]
    ds_write_addtid_b32 v136 offset:23728
    ds_write_addtid_b32 v137 offset:25792
    ds_write_addtid_b32 v138 offset:27856
    ds_write_addtid_b32 v139 offset:29920
    v_mfma_f32_32x32x16_f16 v[28:43], v[92:95], v[60:63], v[28:43]
    ds_read_b128 v[108:111], v17 offset:0
    ds_read_b128 v[112:115], v17 offset:32
    ds_read_b128 v[116:119], v17 offset:64
    ds_read_b128 v[120:123], v17 offset:96
    v_mfma_f32_32x32x16_f16 v[28:43], v[96:99], v[64:67], v[28:43]
    ds_read_b128 v[124:127], v17 offset:128
    ds_read_b128 v[128:131], v17 offset:160
    ds_read_b128 v[132:135], v17 offset:192
    ds_read_b128 v[136:139], v17 offset:224
    v_mfma_f32_32x32x16_f16 v[28:43], v[100:103], v[68:71], v[28:43]
    ds_write_addtid_b32 v140 offset:0
    ds_write_addtid_b32 v141 offset:2064
    ds_write_addtid_b32 v142 offset:4128
    ds_write_addtid_b32 v143 offset:6192
    v_mfma_f32_32x32x16_f16 v[28:43], v[104:107], v[72:75], v[28:43]
    ds_write_addtid_b32 v144 offset:16512
    ds_write_addtid_b32 v145 offset:18576
    ds_write_addtid_b32 v146 offset:20640
    ds_write_addtid_b32 v147 offset:22704
    ds_write_addtid_b32 v148 offset:1024
    ds_write_addtid_b32 v149 offset:8256
    ds_write_addtid_b32 v150 offset:12384
    ds_write_addtid_b32 v151 offset:14448
    ds_write_addtid_b32 v151 offset:24768
    ds_write_addtid_b32 v151 offset:26832
    ds_write_addtid_b32 v152 offset:28896
    ds_write_addtid_b32 v153 offset:30960
    ds_write_addtid_b32 v153 offset:9280
    ds_write_addtid_b32 v154 offset:3088
    ds_write_addtid_b32 v155 offset:5152
    ds_write_addtid_b32 v156 offset:7216
    ds_write_addtid_b32 v157 offset:11344
    ds_write_addtid_b32 v158 offset:13408
    ds_write_addtid_b32 v159 offset:15472
    ds_write_addtid_b32 v160 offset:17536
    ds_write_addtid_b32 v161 offset:19600
    ds_write_addtid_b32 v162 offset:25792
    ds_write_addtid_b32 v163 offset:27856
    ds_write_addtid_b32 v164 offset:21664
    ds_write_addtid_b32 v165 offset:23728
    ds_write_addtid_b32 v166 offset:29920
    ds_write_addtid_b32 v167 offset:10320
    ds_read_b32 v15, v13 offset:32400
    ds_read_b128 v[140:143], v16 offset:0
    ds_read_b128 v[144:147], v16 offset:32
    ds_read_b128 v[148:151], v16 offset:64
    ds_read_b128 v[152:155], v16 offset:96
    ds_read_b128 v[156:159], v16 offset:128
    ds_read_b128 v[160:163], v16 offset:160
    ds_read_b128 v[164:167], v16 offset:192
    ds_read_b128 v[168:171], v16 offset:224
    s_waitcnt lgkmcnt(7)
    v_mfma_f32_32x32x16_f16 v[28:43], v[140:143], v[108:111], v[28:43]
    s_waitcnt lgkmcnt(6)
    v_mfma_f32_32x32x16_f16 v[28:43], v[144:147], v[112:115], v[28:43]
    s_waitcnt lgkmcnt(5)
    v_mfma_f32_32x32x16_f16 v[28:43], v[148:151], v[116:119], v[28:43]
    s_waitcnt lgkmcnt(4)
    v_mfma_f32_32x32x16_f16 v[28:43], v[152:155], v[120:123], v[28:43]
    s_waitcnt lgkmcnt(3)
    v_mfma_f32_32x32x16_f16 v[28:43], v[156:159], v[124:127], v[28:43]
    s_waitcnt lgkmcnt(2)
    v_mfma_f32_32x32x16_f16 v[28:43], v[160:163], v[128:131], v[28:43]
    s_waitcnt lgkmcnt(1)
    v_mfma_f32_32x32x16_f16 v[28:43], v[164:167], v[132:135], v[28:43]
    s_waitcnt lgkmcnt(0)
    v_mfma_f32_32x32x16_f16 v[28:43], v[168:171], v[136:139], v[28:43]
    v_cmp_ne_u32 vcc, s67, v15
    s_nop 4
    s_cbranch_vccz Lv_9
    v_and_b32 v14, 3, v1
    v_lshlrev_b32 v14, 2, v14
    s_mov_b32 s68, 2000000
Lab_10:
    ds_read_b32 v15, v14 offset:32400
    s_waitcnt lgkmcnt(0)
    v_cmp_ne_u32 vcc, s67, v15
    s_sub_u32 s68, s68, 1
    s_nop 3
    s_cbranch_vccz Lae_11
    s_cmp_lg_u32 s68, 0
    s_cbranch_scc1 Lab_10
Lae_11:
Lv_9:
    s_add_u32 s72, s58, 147456
    v_lshl_add_u32 v13, v1, 4, s72
    v_xor_b32 v10, 0x1000, v13
    s_mul_i32 s73, s48, 8320
    s_waitcnt vmcnt(2)
    s_cmp_eq_u32 s47, 0
    s_cbranch_scc0 Lp_12
    v_pk_mul_f32 v[40:41], v[40:41], v[18:19] op_sel_hi:[1,0]
    v_pk_mul_f32 v[42:43], v[42:43], v[18:19] op_sel_hi:[1,0]
    ds_write_b128 v13, v[40:43] offset:3072
    s_lshl_b32 s70, s59, 2
    v_mov_b32 v14, s70
    v_mov_b32 v15, s67
    ds_write_b32 v14, v15 offset:32272
    v_and_b32 v14, 3, v1
    v_lshlrev_b32 v14, 2, v14
    s_mov_b32 s68, 2000000
Lab_14:
    ds_read_b32 v15, v14 offset:32272
    ds_read_b128 v[60:63], v10 offset:0
    ds_read_b128 v[64:67], v10 offset:1024
    ds_read_b128 v[68:71], v10 offset:2048
    s_waitcnt lgkmcnt(0)
    v_cmp_ne_u32 vcc, s67, v15
    s_sub_u32 s68, s68, 1
    s_nop 3
    s_cbranch_vccz Lae_15
    s_cmp_lg_u32 s68, 0
    s_cbranch_scc1 Lab_14
Lae_15:
    ds_write_b128 v185, v[192:195] offset:0
    ds_write_b128 v185, v[196:199] offset:512
    v_lshl_add_u32 v13, v1, 5, s73
    v_cmp_eq_u32 vcc, 0, v1
    v_mov_b32 v15, s79
    s_nop 0
    v_cndmask_b32 v15, 0, v15, vcc
    v_add_f32 v60, v60, v15
    v_pk_fma_f32 v[28:29], v[28:29], v[18:19], v[60:61] op_sel_hi:[1,0,1]
    v_pk_fma_f32 v[30:31], v[30:31], v[18:19], v[62:63] op_sel_hi:[1,0,1]
    v_pk_fma_f32 v[32:33], v[32:33], v[18:19], v[64:65] op_sel_hi:[1,0,1]
    v_pk_fma_f32 v[34:35], v[34:35], v[18:19], v[66:67] op_sel_hi:[1,0,1]
    v_pk_fma_f32 v[36:37], v[36:37], v[18:19], v[68:69] op_sel_hi:[1,0,1]
    v_pk_fma_f32 v[38:39], v[38:39], v[18:19], v[70:71] op_sel_hi:[1,0,1]
    v_cvt_pk_bf16_f32 v76, v29, v28
    v_cvt_pk_bf16_f32 v77, v30, v29
    v_cvt_pk_bf16_f32 v78, v31, v30
    v_cvt_pk_bf16_f32 v79, v32, v31
    v_cvt_pk_bf16_f32 v80, v33, v32
    v_cvt_pk_bf16_f32 v81, v34, v33
    v_cvt_pk_bf16_f32 v82, v35, v34
    v_cvt_pk_bf16_f32 v83, v36, v35
    ds_write_b128 v13, v[76:79] offset:64
    ds_write_b128 v13, v[80:83] offset:80
    v_cvt_pk_bf16_f32 v84, v37, v37
    v_cvt_pk_bf16_f32 v85, v37, v37
    v_cvt_pk_bf16_f32 v86, v38, v37
    v_cvt_pk_bf16_f32 v87, v38, v38
    v_cvt_pk_bf16_f32 v88, v38, v38
    v_cvt_pk_bf16_f32 v89, v39, v38
    v_cvt_pk_bf16_f32 v90, v39, v39
    v_cvt_pk_bf16_f32 v91, v39, v39
    ds_write_b128 v13, v[84:87] offset:2112
    ds_write_b128 v13, v[88:91] offset:2128
    v_readfirstlane_b32 s70, v76
    s_nop 0
    s_lshr_b32 s70, s70, 16
    v_mov_b32 v14, s70
    v_and_b32 v15, 15, v1
    v_cmp_eq_u32 vcc, 15, v15
    s_nop 1
    v_cndmask_b32 v14, 0, v14, vcc
    v_lshl_add_u32 v15, v15, 2, s73
    ds_write_b32 v15, v14
    s_branch Lp_13
Lp_12:
    v_pk_mul_f32 v[28:29], v[28:29], v[18:19] op_sel_hi:[1,0]
    v_pk_mul_f32 v[30:31], v[30:31], v[18:19] op_sel_hi:[1,0]
    ds_write_b128 v13, v[28:31] offset:0
    v_pk_mul_f32 v[32:33], v[32:33], v[18:19] op_sel_hi:[1,0]
    v_pk_mul_f32 v[34:35], v[34:35], v[18:19] op_sel_hi:[1,0]
    ds_write_b128 v13, v[32:35] offset:1024
    v_pk_mul_f32 v[36:37], v[36:37], v[18:19] op_sel_hi:[1,0]
    v_pk_mul_f32 v[38:39], v[38:39], v[18:19] op_sel_hi:[1,0]
    ds_write_b128 v13, v[36:39] offset:2048
    s_lshl_b32 s70, s59, 2
    v_mov_b32 v14, s70
    v_mov_b32 v15, s67
    ds_write_b32 v14, v15 offset:32272
    v_and_b32 v14, 3, v1
    v_lshlrev_b32 v14, 2, v14
    s_mov_b32 s68, 2000000
Lab_16:
    ds_read_b32 v15, v14 offset:32272
    ds_read_b128 v[72:75], v10 offset:3072
    s_waitcnt lgkmcnt(0)
    v_cmp_ne_u32 vcc, s67, v15
    s_sub_u32 s68, s68, 1
    s_nop 3
    s_cbranch_vccz Lae_17
    s_cmp_lg_u32 s68, 0
    s_cbranch_scc1 Lab_16
Lae_17:
    ds_write_b128 v185, v[192:195] offset:0
    ds_write_b128 v185, v[196:199] offset:512
    v_lshl_add_u32 v13, v1, 5, s73
    v_and_b32 v14, 1, v1
    v_cmp_eq_u32 vcc, 1, v14
    v_pk_fma_f32 v[40:41], v[40:41], v[18:19], v[72:73] op_sel_hi:[1,0,1]
    v_pk_fma_f32 v[42:43], v[42:43], v[18:19], v[74:75] op_sel_hi:[1,0,1]
    v_cndmask_b32 v44, v40, v41, vcc
    v_cndmask_b32 v45, v42, v43, vcc
    v_cvt_pk_bf16_f32 v92, v40, v40
    v_cvt_pk_bf16_f32 v93, v40, v40
    v_cvt_pk_bf16_f32 v94, v40, v40
    v_cvt_pk_bf16_f32 v95, v44, v40
    v_cvt_pk_bf16_f32 v96, v41, v44
    v_cvt_pk_bf16_f32 v97, v41, v41
    v_cvt_pk_bf16_f32 v98, v41, v41
    v_cvt_pk_bf16_f32 v99, v41, v41
    ds_write_b128 v13, v[92:95] offset:4160
    ds_write_b128 v13, v[96:99] offset:4176
    v_cvt_pk_bf16_f32 v100, v42, v42
    v_cvt_pk_bf16_f32 v101, v42, v42
    v_cvt_pk_bf16_f32 v102, v42, v42
    v_cvt_pk_bf16_f32 v103, v45, v42
    v_cvt_pk_bf16_f32 v104, v43, v45
    v_cvt_pk_bf16_f32 v105, v43, v43
    v_cvt_pk_bf16_f32 v106, v43, v43
    v_cvt_pk_bf16_f32 v107, v43, v43
    ds_write_b128 v13, v[100:103] offset:6208
    ds_write_b128 v13, v[104:107] offset:6224
    s_mul_i32 s73, s48, 4608
    v_lshl_add_u32 v15, v1, 3, s73
    v_mov_b32 v76, 0
    v_mov_b32 v77, 0
    ds_write_b64 v15, v[76:77] offset:16640
Lp_13:
    s_lshl_b32 s70, s59, 2
    v_mov_b32 v14, s70
    v_mov_b32 v15, s67
    ds_write_b32 v14, v15 offset:32288
    v_and_b32 v14, 3, v1
    v_lshlrev_b32 v14, 2, v14
    s_mov_b32 s68, 2000000
Lab_18:
    ds_read_b32 v15, v14 offset:32288
    ds_read2_b32 v[44:45], v172 offset0:6 offset1:4
    ds_read2_b32 v[46:47], v172 offset0:2 offset1:0
    ds_read_b128 v[108:111], v180 offset:192
    ds_read_b128 v[112:115], v180 offset:704
    ds_read_b128 v[116:119], v180 offset:1216
    ds_read_b128 v[120:123], v180 offset:1728
    ds_read_b128 v[124:127], v180 offset:2240
    ds_read_b128 v[128:131], v180 offset:2752
    ds_read_b128 v[132:135], v180 offset:3264
    ds_read_b128 v[136:139], v180 offset:3776
    s_waitcnt lgkmcnt(0)
    v_cmp_ne_u32 vcc, s67, v15
    s_sub_u32 s68, s68, 1
    s_nop 3
    s_cbranch_vccz Lae_19
    s_cmp_lg_u32 s68, 0
    s_cbranch_scc1 Lab_18
Lae_19:
    ds_read2_b32 v[48:49], v173 offset0:6 offset1:4
    ds_read2_b32 v[50:51], v173 offset0:2 offset1:0
    ds_read2_b32 v[52:53], v174 offset0:6 offset1:4
    ds_read2_b32 v[54:55], v174 offset0:2 offset1:0
    ds_read2_b32 v[56:57], v175 offset0:6 offset1:4
    ds_read2_b32 v[58:59], v175 offset0:2 offset1:0
    ds_read2_b32 v[60:61], v176 offset0:6 offset1:4
    ds_read2_b32 v[62:63], v176 offset0:2 offset1:0
    ds_read2_b32 v[64:65], v177 offset0:6 offset1:4
    ds_read2_b32 v[66:67], v177 offset0:2 offset1:0
    ds_read2_b32 v[68:69], v178 offset0:6 offset1:4
    ds_read2_b32 v[70:71], v178 offset0:2 offset1:0
    ds_read2_b32 v[72:73], v179 offset0:6 offset1:4
    ds_read2_b32 v[74:75], v179 offset0:2 offset1:0
    s_setprio 1
    v_mfma_f32_16x16x32_bf16 v[12:15], v[44:47], v[108:111], 0
    ds_read_b128 v[140:143], v180 offset:128
    v_mfma_f32_16x16x32_bf16 v[16:19], v[44:47], v[112:115], 0
    ds_read_b128 v[144:147], v180 offset:640
    v_mfma_f32_16x16x32_bf16 v[20:23], v[44:47], v[116:119], 0
    ds_read_b128 v[148:151], v180 offset:1152
    v_mfma_f32_16x16x32_bf16 v[24:27], v[44:47], v[120:123], 0
    ds_read_b128 v[152:155], v180 offset:1664
    v_mfma_f32_16x16x32_bf16 v[28:31], v[44:47], v[124:127], 0
    ds_read_b128 v[156:159], v180 offset:2176
    v_mfma_f32_16x16x32_bf16 v[32:35], v[44:47], v[128:131], 0
    ds_read_b128 v[160:163], v180 offset:2688
    v_mfma_f32_16x16x32_bf16 v[36:39], v[44:47], v[132:135], 0
    ds_read_b128 v[164:167], v180 offset:3200
    v_mfma_f32_16x16x32_bf16 v[40:43], v[44:47], v[136:139], 0
    ds_read_b128 v[168:171], v180 offset:3712
    s_waitcnt lgkmcnt(8)
    v_mfma_f32_16x16x32_bf16 v[16:19], v[48:51], v[108:111], v[16:19]
    ds_read2_b32 v[76:77], v172 offset0:38 offset1:36
    v_mfma_f32_16x16x32_bf16 v[20:23], v[48:51], v[112:115], v[20:23]
    ds_read2_b32 v[78:79], v172 offset0:34 offset1:32
    v_mfma_f32_16x16x32_bf16 v[24:27], v[48:51], v[116:119], v[24:27]
    ds_read2_b32 v[80:81], v173 offset0:38 offset1:36
    v_mfma_f32_16x16x32_bf16 v[28:31], v[48:51], v[120:123], v[28:31]
    ds_read2_b32 v[82:83], v173 offset0:34 offset1:32
    v_mfma_f32_16x16x32_bf16 v[32:35], v[48:51], v[124:127], v[32:35]
    ds_read2_b32 v[84:85], v174 offset0:38 offset1:36
    v_mfma_f32_16x16x32_bf16 v[36:39], v[48:51], v[128:131], v[36:39]
    ds_read2_b32 v[86:87], v174 offset0:34 offset1:32
    v_mfma_f32_16x16x32_bf16 v[40:43], v[48:51], v[132:135], v[40:43]
    ds_read2_b32 v[88:89], v175 offset0:38 offset1:36
    v_mfma_f32_16x16x32_bf16 v[20:23], v[52:55], v[108:111], v[20:23]
    ds_read2_b32 v[90:91], v175 offset0:34 offset1:32
    v_mfma_f32_16x16x32_bf16 v[24:27], v[52:55], v[112:115], v[24:27]
    ds_read2_b32 v[92:93], v176 offset0:38 offset1:36
    v_mfma_f32_16x16x32_bf16 v[28:31], v[52:55], v[116:119], v[28:31]
    ds_read2_b32 v[94:95], v176 offset0:34 offset1:32
    v_mfma_f32_16x16x32_bf16 v[32:35], v[52:55], v[120:123], v[32:35]
    ds_read2_b32 v[96:97], v177 offset0:38 offset1:36
    v_mfma_f32_16x16x32_bf16 v[36:39], v[52:55], v[124:127], v[36:39]
    ds_read2_b32 v[98:99], v177 offset0:34 offset1:32
    v_mfma_f32_16x16x32_bf16 v[40:43], v[52:55], v[128:131], v[40:43]
    ds_read2_b32 v[100:101], v178 offset0:38 offset1:36
    v_mfma_f32_16x16x32_bf16 v[24:27], v[56:59], v[108:111], v[24:27]
    ds_read2_b32 v[102:103], v178 offset0:34 offset1:32
    v_mfma_f32_16x16x32_bf16 v[28:31], v[56:59], v[112:115], v[28:31]
    ds_read2_b32 v[104:105], v179 offset0:38 offset1:36
    v_mfma_f32_16x16x32_bf16 v[32:35], v[56:59], v[116:119], v[32:35]
    ds_read2_b32 v[106:107], v179 offset0:34 offset1:32
    v_mfma_f32_16x16x32_bf16 v[36:39], v[56:59], v[120:123], v[36:39]
    v_mfma_f32_16x16x32_bf16 v[40:43], v[56:59], v[124:127], v[40:43]
    v_mfma_f32_16x16x32_bf16 v[28:31], v[60:63], v[108:111], v[28:31]
    v_mfma_f32_16x16x32_bf16 v[32:35], v[60:63], v[112:115], v[32:35]
    v_mfma_f32_16x16x32_bf16 v[36:39], v[60:63], v[116:119], v[36:39]
    v_mfma_f32_16x16x32_bf16 v[40:43], v[60:63], v[120:123], v[40:43]
    v_mfma_f32_16x16x32_bf16 v[32:35], v[64:67], v[108:111], v[32:35]
    v_mfma_f32_16x16x32_bf16 v[36:39], v[64:67], v[112:115], v[36:39]
    v_mfma_f32_16x16x32_bf16 v[40:43], v[64:67], v[116:119], v[40:43]
    v_mfma_f32_16x16x32_bf16 v[36:39], v[68:71], v[108:111], v[36:39]
    v_mfma_f32_16x16x32_bf16 v[40:43], v[68:71], v[112:115], v[40:43]
    v_mfma_f32_16x16x32_bf16 v[40:43], v[72:75], v[108:111], v[40:43]
    s_waitcnt lgkmcnt(0)
    v_mfma_f32_16x16x32_bf16 v[12:15], v[76:79], v[140:143], v[12:15]
    ds_read_b128 v[108:111], v180 offset:64
    v_mfma_f32_16x16x32_bf16 v[16:19], v[76:79], v[144:147], v[16:19]
    ds_read_b128 v[112:115], v180 offset:576
    v_mfma_f32_16x16x32_bf16 v[20:23], v[76:79], v[148:151], v[20:23]
    ds_read_b128 v[116:119], v180 offset:1088
    v_mfma_f32_16x16x32_bf16 v[24:27], v[76:79], v[152:155], v[24:27]
    ds_read_b128 v[120:123], v180 offset:1600
    v_mfma_f32_16x16x32_bf16 v[28:31], v[76:79], v[156:159], v[28:31]
    ds_read_b128 v[124:127], v180 offset:2112
    v_mfma_f32_16x16x32_bf16 v[32:35], v[76:79], v[160:163], v[32:35]
    ds_read_b128 v[128:131], v180 offset:2624
    v_mfma_f32_16x16x32_bf16 v[36:39], v[76:79], v[164:167], v[36:39]
    ds_read_b128 v[132:135], v180 offset:3136
    v_mfma_f32_16x16x32_bf16 v[40:43], v[76:79], v[168:171], v[40:43]
    ds_read_b128 v[136:139], v180 offset:3648
    v_mfma_f32_16x16x32_bf16 v[16:19], v[80:83], v[140:143], v[16:19]
    ds_read2_b32 v[44:45], v172 offset0:70 offset1:68
    v_mfma_f32_16x16x32_bf16 v[20:23], v[80:83], v[144:147], v[20:23]
    ds_read2_b32 v[46:47], v172 offset0:66 offset1:64
    v_mfma_f32_16x16x32_bf16 v[24:27], v[80:83], v[148:151], v[24:27]
    ds_read2_b32 v[48:49], v173 offset0:70 offset1:68
    v_mfma_f32_16x16x32_bf16 v[28:31], v[80:83], v[152:155], v[28:31]
    ds_read2_b32 v[50:51], v173 offset0:66 offset1:64
    v_mfma_f32_16x16x32_bf16 v[32:35], v[80:83], v[156:159], v[32:35]
    ds_read2_b32 v[52:53], v174 offset0:70 offset1:68
    v_mfma_f32_16x16x32_bf16 v[36:39], v[80:83], v[160:163], v[36:39]
    ds_read2_b32 v[54:55], v174 offset0:66 offset1:64
    v_mfma_f32_16x16x32_bf16 v[40:43], v[80:83], v[164:167], v[40:43]
    ds_read2_b32 v[56:57], v175 offset0:70 offset1:68
    v_mfma_f32_16x16x32_bf16 v[20:23], v[84:87], v[140:143], v[20:23]
    ds_read2_b32 v[58:59], v175 offset0:66 offset1:64
    v_mfma_f32_16x16x32_bf16 v[24:27], v[84:87], v[144:147], v[24:27]
    ds_read2_b32 v[60:61], v176 offset0:70 offset1:68
    v_mfma_f32_16x16x32_bf16 v[28:31], v[84:87], v[148:151], v[28:31]
    ds_read2_b32 v[62:63], v176 offset0:66 offset1:64
    v_mfma_f32_16x16x32_bf16 v[32:35], v[84:87], v[152:155], v[32:35]
    ds_read2_b32 v[64:65], v177 offset0:70 offset1:68
    v_mfma_f32_16x16x32_bf16 v[36:39], v[84:87], v[156:159], v[36:39]
    ds_read2_b32 v[66:67], v177 offset0:66 offset1:64
    v_mfma_f32_16x16x32_bf16 v[40:43], v[84:87], v[160:163], v[40:43]
    ds_read2_b32 v[68:69], v178 offset0:70 offset1:68
    v_mfma_f32_16x16x32_bf16 v[24:27], v[88:91], v[140:143], v[24:27]
    ds_read2_b32 v[70:71], v178 offset0:66 offset1:64
    v_mfma_f32_16x16x32_bf16 v[28:31], v[88:91], v[144:147], v[28:31]
    ds_read2_b32 v[72:73], v179 offset0:70 offset1:68
    v_mfma_f32_16x16x32_bf16 v[32:35], v[88:91], v[148:151], v[32:35]
    ds_read2_b32 v[74:75], v179 offset0:66 offset1:64
    v_mfma_f32_16x16x32_bf16 v[36:39], v[88:91], v[152:155], v[36:39]
    v_mfma_f32_16x16x32_bf16 v[40:43], v[88:91], v[156:159], v[40:43]
    v_mfma_f32_16x16x32_bf16 v[28:31], v[92:95], v[140:143], v[28:31]
    v_mfma_f32_16x16x32_bf16 v[32:35], v[92:95], v[144:147], v[32:35]
    v_mfma_f32_16x16x32_bf16 v[36:39], v[92:95], v[148:151], v[36:39]
    v_mfma_f32_16x16x32_bf16 v[40:43], v[92:95], v[152:155], v[40:43]
    v_mfma_f32_16x16x32_bf16 v[32:35], v[96:99], v[140:143], v[32:35]
    v_mfma_f32_16x16x32_bf16 v[36:39], v[96:99], v[144:147], v[36:39]
    v_mfma_f32_16x16x32_bf16 v[40:43], v[96:99], v[148:151], v[40:43]
    v_mfma_f32_16x16x32_bf16 v[36:39], v[100:103], v[140:143], v[36:39]
    v_mfma_f32_16x16x32_bf16 v[40:43], v[100:103], v[144:147], v[40:43]
    v_mfma_f32_16x16x32_bf16 v[40:43], v[104:107], v[140:143], v[40:43]
    s_waitcnt lgkmcnt(0)
    v_mfma_f32_16x16x32_bf16 v[12:15], v[44:47], v[108:111], v[12:15]
    ds_read_b128 v[140:143], v180 offset:0
    v_mfma_f32_16x16x32_bf16 v[16:19], v[44:47], v[112:115], v[16:19]
    ds_read_b128 v[144:147], v180 offset:512
    v_mfma_f32_16x16x32_bf16 v[20:23], v[44:47], v[116:119], v[20:23]
    ds_read_b128 v[148:151], v180 offset:1024
    v_mfma_f32_16x16x32_bf16 v[24:27], v[44:47], v[120:123], v[24:27]
    ds_read_b128 v[152:155], v180 offset:1536
    v_mfma_f32_16x16x32_bf16 v[28:31], v[44:47], v[124:127], v[28:31]
    ds_read_b128 v[156:159], v180 offset:2048
    v_mfma_f32_16x16x32_bf16 v[32:35], v[44:47], v[128:131], v[32:35]
    ds_read_b128 v[160:163], v180 offset:2560
    v_mfma_f32_16x16x32_bf16 v[36:39], v[44:47], v[132:135], v[36:39]
    ds_read_b128 v[164:167], v180 offset:3072
    v_mfma_f32_16x16x32_bf16 v[40:43], v[44:47], v[136:139], v[40:43]
    ds_read_b128 v[168:171], v180 offset:3584
    v_mfma_f32_16x16x32_bf16 v[16:19], v[48:51], v[108:111], v[16:19]
    ds_read2_b32 v[76:77], v172 offset0:102 offset1:100
    v_mfma_f32_16x16x32_bf16 v[20:23], v[48:51], v[112:115], v[20:23]
    ds_read2_b32 v[78:79], v172 offset0:98 offset1:96
    v_mfma_f32_16x16x32_bf16 v[24:27], v[48:51], v[116:119], v[24:27]
    ds_read2_b32 v[80:81], v173 offset0:102 offset1:100
    v_mfma_f32_16x16x32_bf16 v[28:31], v[48:51], v[120:123], v[28:31]
    ds_read2_b32 v[82:83], v173 offset0:98 offset1:96
    v_mfma_f32_16x16x32_bf16 v[32:35], v[48:51], v[124:127], v[32:35]
    ds_read2_b32 v[84:85], v174 offset0:102 offset1:100
    v_mfma_f32_16x16x32_bf16 v[36:39], v[48:51], v[128:131], v[36:39]
    ds_read2_b32 v[86:87], v174 offset0:98 offset1:96
    v_mfma_f32_16x16x32_bf16 v[40:43], v[48:51], v[132:135], v[40:43]
    ds_read2_b32 v[88:89], v175 offset0:102 offset1:100
    v_mfma_f32_16x16x32_bf16 v[20:23], v[52:55], v[108:111], v[20:23]
    ds_read2_b32 v[90:91], v175 offset0:98 offset1:96
    v_mfma_f32_16x16x32_bf16 v[24:27], v[52:55], v[112:115], v[24:27]
    ds_read2_b32 v[92:93], v176 offset0:102 offset1:100
    v_mfma_f32_16x16x32_bf16 v[28:31], v[52:55], v[116:119], v[28:31]
    ds_read2_b32 v[94:95], v176 offset0:98 offset1:96
    v_mfma_f32_16x16x32_bf16 v[32:35], v[52:55], v[120:123], v[32:35]
    ds_read2_b32 v[96:97], v177 offset0:102 offset1:100
    v_mfma_f32_16x16x32_bf16 v[36:39], v[52:55], v[124:127], v[36:39]
    ds_read2_b32 v[98:99], v177 offset0:98 offset1:96
    v_mfma_f32_16x16x32_bf16 v[40:43], v[52:55], v[128:131], v[40:43]
    ds_read2_b32 v[100:101], v178 offset0:102 offset1:100
    v_mfma_f32_16x16x32_bf16 v[24:27], v[56:59], v[108:111], v[24:27]
    ds_read2_b32 v[102:103], v178 offset0:98 offset1:96
    v_mfma_f32_16x16x32_bf16 v[28:31], v[56:59], v[112:115], v[28:31]
    ds_read2_b32 v[104:105], v179 offset0:102 offset1:100
    v_mfma_f32_16x16x32_bf16 v[32:35], v[56:59], v[116:119], v[32:35]
    ds_read2_b32 v[106:107], v179 offset0:98 offset1:96
    v_mfma_f32_16x16x32_bf16 v[36:39], v[56:59], v[120:123], v[36:39]
    v_mfma_f32_16x16x32_bf16 v[40:43], v[56:59], v[124:127], v[40:43]
    v_mfma_f32_16x16x32_bf16 v[28:31], v[60:63], v[108:111], v[28:31]
    v_mfma_f32_16x16x32_bf16 v[32:35], v[60:63], v[112:115], v[32:35]
    v_mfma_f32_16x16x32_bf16 v[36:39], v[60:63], v[116:119], v[36:39]
    v_mfma_f32_16x16x32_bf16 v[40:43], v[60:63], v[120:123], v[40:43]
    v_mfma_f32_16x16x32_bf16 v[32:35], v[64:67], v[108:111], v[32:35]
    v_mfma_f32_16x16x32_bf16 v[36:39], v[64:67], v[112:115], v[36:39]
    v_mfma_f32_16x16x32_bf16 v[40:43], v[64:67], v[116:119], v[40:43]
    v_mfma_f32_16x16x32_bf16 v[36:39], v[68:71], v[108:111], v[36:39]
    v_mfma_f32_16x16x32_bf16 v[40:43], v[68:71], v[112:115], v[40:43]
    v_mfma_f32_16x16x32_bf16 v[40:43], v[72:75], v[108:111], v[40:43]
    s_waitcnt lgkmcnt(0)
    v_mfma_f32_16x16x32_bf16 v[12:15], v[76:79], v[140:143], v[12:15]
    v_mfma_f32_16x16x32_bf16 v[16:19], v[76:79], v[144:147], v[16:19]
    v_mfma_f32_16x16x32_bf16 v[20:23], v[76:79], v[148:151], v[20:23]
    v_mfma_f32_16x16x32_bf16 v[24:27], v[76:79], v[152:155], v[24:27]
    v_mfma_f32_16x16x32_bf16 v[28:31], v[76:79], v[156:159], v[28:31]
    v_mfma_f32_16x16x32_bf16 v[32:35], v[76:79], v[160:163], v[32:35]
    v_mfma_f32_16x16x32_bf16 v[36:39], v[76:79], v[164:167], v[36:39]
    v_mfma_f32_16x16x32_bf16 v[40:43], v[76:79], v[168:171], v[40:43]
    v_mfma_f32_16x16x32_bf16 v[16:19], v[80:83], v[140:143], v[16:19]
    v_mfma_f32_16x16x32_bf16 v[20:23], v[80:83], v[144:147], v[20:23]
    v_mfma_f32_16x16x32_bf16 v[24:27], v[80:83], v[148:151], v[24:27]
    v_mfma_f32_16x16x32_bf16 v[28:31], v[80:83], v[152:155], v[28:31]
    v_mfma_f32_16x16x32_bf16 v[32:35], v[80:83], v[156:159], v[32:35]
    v_mfma_f32_16x16x32_bf16 v[36:39], v[80:83], v[160:163], v[36:39]
    v_mfma_f32_16x16x32_bf16 v[40:43], v[80:83], v[164:167], v[40:43]
    v_mfma_f32_16x16x32_bf16 v[20:23], v[84:87], v[140:143], v[20:23]
    v_mfma_f32_16x16x32_bf16 v[24:27], v[84:87], v[144:147], v[24:27]
    v_mfma_f32_16x16x32_bf16 v[28:31], v[84:87], v[148:151], v[28:31]
    v_mfma_f32_16x16x32_bf16 v[32:35], v[84:87], v[152:155], v[32:35]
    v_mfma_f32_16x16x32_bf16 v[36:39], v[84:87], v[156:159], v[36:39]
    v_mfma_f32_16x16x32_bf16 v[40:43], v[84:87], v[160:163], v[40:43]
    v_mfma_f32_16x16x32_bf16 v[24:27], v[88:91], v[140:143], v[24:27]
    v_mfma_f32_16x16x32_bf16 v[28:31], v[88:91], v[144:147], v[28:31]
    v_mfma_f32_16x16x32_bf16 v[32:35], v[88:91], v[148:151], v[32:35]
    v_mfma_f32_16x16x32_bf16 v[36:39], v[88:91], v[152:155], v[36:39]
    v_mfma_f32_16x16x32_bf16 v[40:43], v[88:91], v[156:159], v[40:43]
    v_mfma_f32_16x16x32_bf16 v[28:31], v[92:95], v[140:143], v[28:31]
    v_mfma_f32_16x16x32_bf16 v[32:35], v[92:95], v[144:147], v[32:35]
    v_mfma_f32_16x16x32_bf16 v[36:39], v[92:95], v[148:151], v[36:39]
    v_mfma_f32_16x16x32_bf16 v[40:43], v[92:95], v[152:155], v[40:43]
    v_mfma_f32_16x16x32_bf16 v[32:35], v[96:99], v[140:143], v[32:35]
    v_mfma_f32_16x16x32_bf16 v[36:39], v[96:99], v[144:147], v[36:39]
    v_mfma_f32_16x16x32_bf16 v[40:43], v[96:99], v[148:151], v[40:43]
    v_mfma_f32_16x16x32_bf16 v[36:39], v[100:103], v[140:143], v[36:39]
    v_mfma_f32_16x16x32_bf16 v[40:43], v[100:103], v[144:147], v[40:43]
    v_mfma_f32_16x16x32_bf16 v[40:43], v[104:107], v[140:143], v[40:43]
    s_lshl_b32 s70, s59, 12
    s_add_u32 s70, s70, 147456
    v_lshl_add_u32 v5, v1, 4, s70
    s_nop 3
    s_cmp_eq_u32 s47, 0
    s_cbranch_scc0 Lx_20
    ds_write_b128 v5, v[28:31] offset:0
    ds_write_b128 v5, v[32:35] offset:1024
    ds_write_b128 v5, v[36:39] offset:2048
    ds_write_b128 v5, v[40:43] offset:3072
    v_mov_b64 v[44:45], v[12:13]
    v_mov_b64 v[46:47], v[14:15]
    v_mov_b64 v[48:49], v[16:17]
    v_mov_b64 v[50:51], v[18:19]
    v_mov_b64 v[52:53], v[20:21]
    v_mov_b64 v[54:55], v[22:23]
    v_mov_b64 v[56:57], v[24:25]
    v_mov_b64 v[58:59], v[26:27]
    s_branch Lx_21
Lx_20:
    ds_write_b128 v5, v[12:15] offset:0
    ds_write_b128 v5, v[16:19] offset:1024
    ds_write_b128 v5, v[20:23] offset:2048
    ds_write_b128 v5, v[24:27] offset:3072
    v_mov_b64 v[44:45], v[28:29]
    v_mov_b64 v[46:47], v[30:31]
    v_mov_b64 v[48:49], v[32:33]
    v_mov_b64 v[50:51], v[34:35]
    v_mov_b64 v[52:53], v[36:37]
    v_mov_b64 v[54:55], v[38:39]
    v_mov_b64 v[56:57], v[40:41]
    v_mov_b64 v[58:59], v[42:43]
Lx_21:
    v_bfe_u32 v8, v1, 2, 2
    v_mul_u32_u24 v8, 114688, v8
    v_and_b32 v9, 3, v1
    v_lshl_add_u32 v8, v9, 4, v8
    v_and_b32 v9, 48, v1
    v_lshl_add_u32 v8, v9, 2, v8
    s_mul_i32 s72, s47, 1835008
    s_lshl_b32 s71, s74, 8
    s_add_u32 s72, s72, s71
    s_add_u32 s72, s72, 10486784
    v_xor_b32 v5, 0x1000, v5
    s_lshl_b32 s70, s59, 2
    v_mov_b32 v6, s70
    v_mov_b32 v7, s67
    ds_write_b32 v6, v7 offset:32304
    s_lshl_b32 s70, s59, 2
    s_xor_b32 s70, s70, 4
    v_mov_b32 v6, s70
    s_mov_b32 s68, 2000000
Lab_22:
    ds_read_b32 v7, v6 offset:32304
    ds_read_b128 v[60:63], v5 offset:0
    ds_read_b128 v[64:67], v5 offset:1024
    ds_read_b128 v[68:71], v5 offset:2048
    ds_read_b128 v[72:75], v5 offset:3072
    s_waitcnt lgkmcnt(0)
    v_cmp_ne_u32 vcc, s67, v7
    s_sub_u32 s68, s68, 1
    s_nop 3
    s_cbranch_vccz Lae_23
    s_cmp_lg_u32 s68, 0
    s_cbranch_scc1 Lab_22
Lae_23:
    v_add_f32 v44, v44, v60
    v_add_f32 v45, v45, v61
    v_add_f32 v46, v46, v62
    v_add_f32 v47, v47, v63
    v_cvt_pk_bf16_f32 v44, v44, v45
    v_cvt_pk_bf16_f32 v46, v46, v47
    v_mov_b32 v45, s67
    v_mov_b32 v47, s67
    buffer_store_dwordx4 v[44:47], v8, s[20:23], s72 offen sc1
    s_add_u32 s72, s72, 458752
    v_add_f32 v48, v48, v64
    v_add_f32 v49, v49, v65
    v_add_f32 v50, v50, v66
    v_add_f32 v51, v51, v67
    v_cvt_pk_bf16_f32 v48, v48, v49
    v_cvt_pk_bf16_f32 v50, v50, v51
    v_mov_b32 v49, s67
    v_mov_b32 v51, s67
    buffer_store_dwordx4 v[48:51], v8, s[20:23], s72 offen sc1
    s_add_u32 s72, s72, 458752
    v_add_f32 v52, v52, v68
    v_add_f32 v53, v53, v69
    v_add_f32 v54, v54, v70
    v_add_f32 v55, v55, v71
    v_cvt_pk_bf16_f32 v52, v52, v53
    v_cvt_pk_bf16_f32 v54, v54, v55
    v_mov_b32 v53, s67
    v_mov_b32 v55, s67
    buffer_store_dwordx4 v[52:55], v8, s[20:23], s72 offen sc1
    s_add_u32 s72, s72, 458752
    v_add_f32 v56, v56, v72
    v_add_f32 v57, v57, v73
    v_add_f32 v58, v58, v74
    v_add_f32 v59, v59, v75
    v_cvt_pk_bf16_f32 v56, v56, v57
    v_cvt_pk_bf16_f32 v58, v58, v59
    v_mov_b32 v57, s67
    v_mov_b32 v59, s67
    buffer_store_dwordx4 v[56:59], v8, s[20:23], s72 offen sc1
    s_setprio 0
    v_lshrrev_b32 v78, 3, v1
    s_lshl_b32 s72, s59, 4
    v_add_u32 v79, s72, v78
    v_mul_u32_u24 v80, 48, v79
    v_and_b32 v79, 7, v1
    v_xor_b32 v79, v79, v78
    v_lshlrev_b32 v79, 4, v79
    v_lshl_add_u32 v76, v78, 7, v79
    s_lshl_b32 s72, s59, 14
    s_add_u32 s72, s72, 32768
    v_bfe_u32 v79, v1, 2, 1
    v_mul_u32_u24 v79, 8320, v79
    v_add_u32 v80, v80, v79
    v_bfe_u32 v79, v1, 1, 1
    v_lshl_add_u32 v80, v79, 12, v80
    v_and_b32 v79, 1, v1
    v_lshl_add_u32 v80, v79, 4, v80
    v_add_u32 v76, s72, v76
    s_lshl_b32 s71, s64, 6
    s_lshl_b32 s72, s59, 4
    s_add_u32 s71, s71, s72
    s_mul_i32 s70, s63, 448
    s_add_u32 s70, s70, s71
    s_lshl_b32 s70, s70, 8
    s_add_u32 s70, s70, 10486784
    v_lshlrev_b32 v5, 4, v1
    v_lshrrev_b32 v6, 4, v1
    v_mul_u32_u24 v6, 144, v6
    v_and_b32 v7, 3, v1
    v_lshl_add_u32 v6, v7, 5, v6
    v_bfe_u32 v8, v1, 2, 2
    v_lshl_add_u32 v6, v8, 3, v6
    s_mul_i32 s72, s48, 8320
    s_lshl_b32 s71, s47, 12
    s_add_u32 s72, s72, s71
    v_add_u32 v6, s72, v6
    v_mul_u32_u24 v8, 144, v8
    v_lshl_add_u32 v8, v7, 3, v8
    v_and_b32 v7, 48, v1
    v_lshl_add_u32 v8, v7, 1, v8
    v_add_u32 v8, s72, v8
    v_mul_u32_u24 v9, 48, v1
    v_add_u32 v9, s72, v9
    v_add_u32 v7, 1152, v6
    s_mov_b32 s73, s70
    s_lshl_b32 s70, s59, 2
    v_mov_b32 v12, s70
    s_mov_b32 s68, 2000000
Lab_24:
    ds_read_b32 v13, v12 offset:32320
    s_waitcnt lgkmcnt(0)
    v_cmp_ne_u32 vcc, s67, v13
    s_sub_u32 s68, s68, 1
    s_nop 3
    s_cbranch_vccz Lae_25
    s_sleep 2
    s_cmp_lg_u32 s68, 0
    s_cbranch_scc1 Lab_24
Lae_25:
    buffer_load_dwordx4 v[12:15], v5, s[20:23], s73 offen offset:0 sc1
    buffer_load_dwordx4 v[16:19], v5, s[20:23], s73 offen offset:1024 sc1
    buffer_load_dwordx4 v[20:23], v5, s[20:23], s73 offen offset:2048 sc1
    buffer_load_dwordx4 v[24:27], v5, s[20:23], s73 offen offset:3072 sc1
    s_add_u32 s70, s58, 81920
    v_add_u32 v28, s70, v5
    ds_write_b128 v28, v[200:203] offset:0
    ds_write_b128 v28, v[204:207] offset:1024
    ds_write_b128 v28, v[208:211] offset:2048
    ds_write_b128 v28, v[212:215] offset:3072
    ds_write_b128 v28, v[216:219] offset:16384
    ds_write_b128 v28, v[236:239] offset:17408
    ds_write_b128 v28, v[188:191] offset:18432
    ds_write_b128 v28, v[252:255] offset:19456
    s_lshl_b32 s70, s59, 2
    v_mov_b32 v30, s70
    v_mov_b32 v31, s67
    ds_write_b32 v30, v31 offset:32432
    s_waitcnt vmcnt(8)
    v_cmp_ne_u32 vcc, s67, v231
    v_cmp_ne_u32 s[76:77], s67, v233
    s_nop 0
    s_or_b64 vcc, vcc, s[76:77]
    s_nop 0
    s_cbranch_vccz Lok_27
    s_mov_b32 s68, 200000
Lspin_26:
    buffer_load_dwordx2 v[230:231], v235, s[20:23], 0 offen offset:0 sc1
    buffer_load_dwordx2 v[232:233], v235, s[20:23], 0 offen offset:64 sc1
    s_waitcnt vmcnt(0)
    v_cmp_ne_u32 vcc, s67, v231
    v_cmp_ne_u32 s[76:77], s67, v233
    s_nop 0
    s_or_b64 vcc, vcc, s[76:77]
    s_nop 0
    s_cbranch_vccz Lok_27
    s_sleep 2
    s_sub_u32 s68, s68, 1
    s_cmp_lg_u32 s68, 0
    s_cbranch_scc1 Lspin_26
Lok_27:
    v_lshlrev_b32 v84, 16, v222
    v_and_b32 v85, 0xffff0000, v222
    v_lshlrev_b32 v86, 16, v223
    v_and_b32 v87, 0xffff0000, v223
    v_lshlrev_b32 v88, 16, v224
    v_and_b32 v89, 0xffff0000, v224
    v_lshlrev_b32 v90, 16, v225
    v_and_b32 v91, 0xffff0000, v225
    v_lshlrev_b32 v92, 16, v226
    v_and_b32 v93, 0xffff0000, v226
    v_lshlrev_b32 v94, 16, v227
    v_and_b32 v95, 0xffff0000, v227
    v_lshlrev_b32 v96, 16, v228
    v_and_b32 v97, 0xffff0000, v228
    v_lshlrev_b32 v98, 16, v229
    v_and_b32 v99, 0xffff0000, v229
    s_waitcnt vmcnt(0)
    v_cmp_ne_u32 vcc, s67, v13
    v_cmp_ne_u32 s[76:77], s67, v15
    s_nop 0
    s_or_b64 vcc, vcc, s[76:77]
    v_cmp_ne_u32 s[76:77], s67, v17
    s_nop 0
    s_or_b64 vcc, vcc, s[76:77]
    v_cmp_ne_u32 s[76:77], s67, v19
    s_nop 0
    s_or_b64 vcc, vcc, s[76:77]
    v_cmp_ne_u32 s[76:77], s67, v21
    s_nop 0
    s_or_b64 vcc, vcc, s[76:77]
    v_cmp_ne_u32 s[76:77], s67, v23
    s_nop 0
    s_or_b64 vcc, vcc, s[76:77]
    v_cmp_ne_u32 s[76:77], s67, v25
    s_nop 0
    s_or_b64 vcc, vcc, s[76:77]
    v_cmp_ne_u32 s[76:77], s67, v27
    s_nop 0
    s_or_b64 vcc, vcc, s[76:77]
    s_nop 0
    s_cbranch_vccz Lok_29
    s_mov_b32 s68, 200000
Lspin_28:
    buffer_load_dwordx4 v[12:15], v5, s[20:23], s73 offen offset:0 sc1
    buffer_load_dwordx4 v[16:19], v5, s[20:23], s73 offen offset:1024 sc1
    buffer_load_dwordx4 v[20:23], v5, s[20:23], s73 offen offset:2048 sc1
    buffer_load_dwordx4 v[24:27], v5, s[20:23], s73 offen offset:3072 sc1
    s_waitcnt vmcnt(0)
    v_cmp_ne_u32 vcc, s67, v13
    v_cmp_ne_u32 s[76:77], s67, v15
    s_nop 0
    s_or_b64 vcc, vcc, s[76:77]
    v_cmp_ne_u32 s[76:77], s67, v17
    s_nop 0
    s_or_b64 vcc, vcc, s[76:77]
    v_cmp_ne_u32 s[76:77], s67, v19
    s_nop 0
    s_or_b64 vcc, vcc, s[76:77]
    v_cmp_ne_u32 s[76:77], s67, v21
    s_nop 0
    s_or_b64 vcc, vcc, s[76:77]
    v_cmp_ne_u32 s[76:77], s67, v23
    s_nop 0
    s_or_b64 vcc, vcc, s[76:77]
    v_cmp_ne_u32 s[76:77], s67, v25
    s_nop 0
    s_or_b64 vcc, vcc, s[76:77]
    v_cmp_ne_u32 s[76:77], s67, v27
    s_nop 0
    s_or_b64 vcc, vcc, s[76:77]
    s_nop 0
    s_cbranch_vccz Lok_29
    s_sleep 4
    s_sub_u32 s68, s68, 1
    s_cmp_lg_u32 s68, 0
    s_cbranch_scc1 Lspin_28
Lok_29:
    ds_write2_b32 v6, v12, v14 offset0:0 offset1:1
    ds_write2_b32 v6, v16, v18 offset0:144 offset1:145
    ds_write2_b32 v7, v20, v22 offset0:0 offset1:1
    ds_write2_b32 v7, v24, v26 offset0:144 offset1:145
    ds_read_b64_tr_b16 v[28:29], v8 offset:0
    ds_read_b64_tr_b16 v[30:31], v8 offset:576
    ds_read_b64_tr_b16 v[32:33], v8 offset:1152
    ds_read_b64_tr_b16 v[34:35], v8 offset:1728
    s_waitcnt lgkmcnt(0)
    ds_write_b128 v9, v[28:31] offset:0
    ds_write_b128 v9, v[32:35] offset:16
    s_lshl_b32 s70, s59, 2
    v_mov_b32 v82, s70
    v_mov_b32 v83, s67
    ds_write_b32 v82, v83 offset:32368
    v_and_b32 v82, 3, v1
    v_lshlrev_b32 v82, 2, v82
    s_mov_b32 s68, 2000000
Lab_30:
    ds_read_b32 v83, v82 offset:32368
    ds_read_b128 v[100:103], v80 offset:0
    ds_read_b128 v[104:107], v80 offset:384
    s_waitcnt lgkmcnt(0)
    v_cmp_ne_u32 vcc, s67, v83
    s_sub_u32 s68, s68, 1
    s_nop 3
    s_cbranch_vccz Lae_31
    s_cmp_lg_u32 s68, 0
    s_cbranch_scc1 Lab_30
Lae_31:
    v_lshlrev_b32 v222, 16, v100
    v_and_b32 v223, 0xffff0000, v100
    v_add_f32 v84, v84, v222
    v_add_f32 v85, v85, v223
    v_lshlrev_b32 v222, 16, v101
    v_and_b32 v223, 0xffff0000, v101
    v_add_f32 v86, v86, v222
    v_add_f32 v87, v87, v223
    v_lshlrev_b32 v222, 16, v102
    v_and_b32 v223, 0xffff0000, v102
    v_add_f32 v88, v88, v222
    v_add_f32 v89, v89, v223
    v_lshlrev_b32 v222, 16, v103
    v_and_b32 v223, 0xffff0000, v103
    v_add_f32 v90, v90, v222
    v_add_f32 v91, v91, v223
    v_lshlrev_b32 v222, 16, v104
    v_and_b32 v223, 0xffff0000, v104
    v_add_f32 v92, v92, v222
    v_add_f32 v93, v93, v223
    v_lshlrev_b32 v222, 16, v105
    v_and_b32 v223, 0xffff0000, v105
    v_add_f32 v94, v94, v222
    v_add_f32 v95, v95, v223
    v_lshlrev_b32 v222, 16, v106
    v_and_b32 v223, 0xffff0000, v106
    v_add_f32 v96, v96, v222
    v_add_f32 v97, v97, v223
    v_lshlrev_b32 v222, 16, v107
    v_and_b32 v223, 0xffff0000, v107
    v_add_f32 v98, v98, v222
    v_add_f32 v99, v99, v223
    s_movk_i32 s71, 7168
    s_mov_b32 s72, 0x3f80
    s_mov_b32 s73, 0x3f800000
    s_barrier
    ds_read_b128 v[108:111], v76 offset:0
    ds_read_b128 v[112:115], v76 offset:4096
    ds_read_b128 v[116:119], v76 offset:8192
    ds_read_b128 v[120:123], v76 offset:12288
    ds_read_b128 v[124:127], v76 offset:1024
    ds_read_b128 v[128:131], v76 offset:5120
    ds_read_b128 v[132:135], v76 offset:9216
    ds_read_b128 v[136:139], v76 offset:13312
    s_waitcnt lgkmcnt(7)
    v_lshlrev_b32 v140, 16, v108
    v_and_b32 v141, 0xffff0000, v108
    v_lshlrev_b32 v142, 16, v109
    v_and_b32 v143, 0xffff0000, v109
    v_lshlrev_b32 v144, 16, v110
    v_and_b32 v145, 0xffff0000, v110
    v_lshlrev_b32 v146, 16, v111
    v_and_b32 v147, 0xffff0000, v111
    s_waitcnt lgkmcnt(6)
    v_dot2c_f32_bf16 v140, s72, v112
    v_dot2c_f32_bf16 v141, s73, v112
    v_dot2c_f32_bf16 v142, s72, v113
    v_dot2c_f32_bf16 v143, s73, v113
    v_dot2c_f32_bf16 v144, s72, v114
    v_dot2c_f32_bf16 v145, s73, v114
    v_dot2c_f32_bf16 v146, s72, v115
    v_dot2c_f32_bf16 v147, s73, v115
    s_waitcnt lgkmcnt(5)
    v_dot2c_f32_bf16 v140, s72, v116
    v_dot2c_f32_bf16 v141, s73, v116
    v_dot2c_f32_bf16 v142, s72, v117
    v_dot2c_f32_bf16 v143, s73, v117
    v_dot2c_f32_bf16 v144, s72, v118
    v_dot2c_f32_bf16 v145, s73, v118
    v_dot2c_f32_bf16 v146, s72, v119
    v_dot2c_f32_bf16 v147, s73, v119
    s_waitcnt lgkmcnt(4)
    v_dot2c_f32_bf16 v140, s72, v120
    v_dot2c_f32_bf16 v141, s73, v120
    v_dot2c_f32_bf16 v142, s72, v121
    v_dot2c_f32_bf16 v143, s73, v121
    v_dot2c_f32_bf16 v144, s72, v122
    v_dot2c_f32_bf16 v145, s73, v122
    v_dot2c_f32_bf16 v146, s72, v123
    v_dot2c_f32_bf16 v147, s73, v123
    v_pk_fma_f32 v[84:85], v[140:141], v[230:231], v[84:85] op_sel_hi:[1,0,1]
    v_pk_fma_f32 v[86:87], v[142:143], v[230:231], v[86:87] op_sel_hi:[1,0,1]
    v_pk_fma_f32 v[88:89], v[144:145], v[230:231], v[88:89] op_sel_hi:[1,0,1]
    v_pk_fma_f32 v[90:91], v[146:147], v[230:231], v[90:91] op_sel_hi:[1,0,1]
    v_cvt_pk_bf16_f32 v108, v84, v85
    v_cvt_pk_bf16_f32 v109, v86, v87
    v_cvt_pk_bf16_f32 v110, v88, v89
    v_cvt_pk_bf16_f32 v111, v90, v91
    buffer_store_dwordx4 v[108:111], v234, s[24:27], 0 offen
    s_waitcnt lgkmcnt(3)
    v_lshlrev_b32 v148, 16, v124
    v_and_b32 v149, 0xffff0000, v124
    v_lshlrev_b32 v150, 16, v125
    v_and_b32 v151, 0xffff0000, v125
    v_lshlrev_b32 v152, 16, v126
    v_and_b32 v153, 0xffff0000, v126
    v_lshlrev_b32 v154, 16, v127
    v_and_b32 v155, 0xffff0000, v127
    s_waitcnt lgkmcnt(2)
    v_dot2c_f32_bf16 v148, s72, v128
    v_dot2c_f32_bf16 v149, s73, v128
    v_dot2c_f32_bf16 v150, s72, v129
    v_dot2c_f32_bf16 v151, s73, v129
    v_dot2c_f32_bf16 v152, s72, v130
    v_dot2c_f32_bf16 v153, s73, v130
    v_dot2c_f32_bf16 v154, s72, v131
    v_dot2c_f32_bf16 v155, s73, v131
    s_waitcnt lgkmcnt(1)
    v_dot2c_f32_bf16 v148, s72, v132
    v_dot2c_f32_bf16 v149, s73, v132
    v_dot2c_f32_bf16 v150, s72, v133
    v_dot2c_f32_bf16 v151, s73, v133
    v_dot2c_f32_bf16 v152, s72, v134
    v_dot2c_f32_bf16 v153, s73, v134
    v_dot2c_f32_bf16 v154, s72, v135
    v_dot2c_f32_bf16 v155, s73, v135
    s_waitcnt lgkmcnt(0)
    v_dot2c_f32_bf16 v148, s72, v136
    v_dot2c_f32_bf16 v149, s73, v136
    v_dot2c_f32_bf16 v150, s72, v137
    v_dot2c_f32_bf16 v151, s73, v137
    v_dot2c_f32_bf16 v152, s72, v138
    v_dot2c_f32_bf16 v153, s73, v138
    v_dot2c_f32_bf16 v154, s72, v139
    v_dot2c_f32_bf16 v155, s73, v139
    v_pk_fma_f32 v[92:93], v[148:149], v[232:233], v[92:93] op_sel_hi:[1,0,1]
    v_pk_fma_f32 v[94:95], v[150:151], v[232:233], v[94:95] op_sel_hi:[1,0,1]
    v_pk_fma_f32 v[96:97], v[152:153], v[232:233], v[96:97] op_sel_hi:[1,0,1]
    v_pk_fma_f32 v[98:99], v[154:155], v[232:233], v[98:99] op_sel_hi:[1,0,1]
    v_cvt_pk_bf16_f32 v124, v92, v93
    v_cvt_pk_bf16_f32 v125, v94, v95
    v_cvt_pk_bf16_f32 v126, v96, v97
    v_cvt_pk_bf16_f32 v127, v98, v99
    buffer_store_dwordx4 v[124:127], v234, s[24:27], s71 offen
    s_endpgm
L_m:
    s_mov_b64 s[18:19], s[10:11]
    s_mov_b64 s[26:27], s[6:7]
    s_mov_b32 s22, 0x10000000
    s_mov_b32 s23, s7
    s_movk_i32 s30, 256
    s_mov_b32 s31, s7
    s_and_b32 s73, s2, 7
    s_lshr_b32 s71, s2, 3
    s_sub_u32 s71, s71, 4
    s_mul_i32 s53, s71, 37
    s_lshr_b32 s53, s53, 8
    s_mul_i32 s72, s53, 7
    s_sub_u32 s64, s71, s72
    s_lshl2_add_u32 s63, s73, s53
    s_mul_i32 s65, s73, 28
    s_add_u32 s65, s65, s71
    v_lshrrev_b32 v5, 3, v1
    v_and_b32 v6, 7, v1
    v_lshrrev_b32 v7, 4, v1
    v_mul_u32_u24 v15, 896, v5
    v_lshlrev_b32 v14, 1, v7
    v_xor_b32 v14, v14, v6
    v_lshl_add_u32 v248, v14, 4, v15
    v_mov_b32 v0, v248
    s_lshr_b32 s48, s60, 1
    s_and_b32 s49, s60, 1
    v_and_b32 v239, 15, v1
    v_lshrrev_b32 v241, 4, v1
    v_bfe_u32 v242, v1, 1, 3
    v_xor_b32 v242, v242, v241
    v_lshlrev_b32 v242, 4, v242
    s_lshl_b32 s70, s48, 13
    s_add_u32 s70, s70, 32768
    v_lshl_add_u32 v239, v239, 7, s70
    v_xad_u32 v234, v242, 0, v239
    v_add_u32 v236, 0x10000, v234
    v_xad_u32 v235, v242, 64, v239
    v_add_u32 v237, 0x10000, v235
    v_bfe_u32 v239, v1, 2, 2
    v_lshl_add_u32 v239, v241, 3, v239
    v_lshlrev_b32 v239, 8, v239
    v_and_b32 v242, 3, v1
    v_lshl_add_u32 v239, v242, 3, v239
    v_bfe_u32 v242, v1, 2, 3
    v_lshl_add_u32 v239, v242, 5, v239
    s_lshl_b32 s70, s49, 7
    v_xor_b32 v239, s70, v239
    v_add_u32 v239, 32768, v239
    s_waitcnt vmcnt(0)
    v_xor_b32 v248, 0, v239
    v_add_u32 v252, 0x10000, v248
    v_xor_b32 v249, 32, v239
    v_add_u32 v253, 0x10000, v249
    v_xor_b32 v250, 64, v239
    v_add_u32 v254, 0x10000, v250
    v_xor_b32 v251, 96, v239
    v_add_u32 v255, 0x10000, v251
    v_lshlrev_b32 v3, 3, v1
    v_lshlrev_b32 v2, 4, v1
    v_lshrrev_b32 v239, 2, v1
    v_lshlrev_b32 v239, 7, v239
    v_and_b32 v240, 3, v1
    v_lshl_add_u32 v239, v240, 3, v239
    v_bfe_u32 v240, v1, 3, 2
    v_lshl_add_u32 v239, v240, 5, v239
    v_add_u32 v239, s58, v239
    s_add_u32 s52, s58, 32768
    v_xor_b32 v244, 0, v239
    v_xor_b32 v245, 32, v239
    v_xor_b32 v246, 64, v239
    v_xor_b32 v247, 96, v239
    s_mul_i32 s51, s60, 401408
    s_lshl_b32 s70, s64, 7
    s_add_u32 s51, s51, s70
    s_mul_i32 s50, s63, 230400
    s_mul_i32 s70, s60, 57344
    s_add_u32 s50, s50, s70
    s_setprio 2
    s_waitcnt lgkmcnt(0)
    s_add_u32 s32, s53, 0
    s_cmp_ge_u32 s32, 4
    s_cselect_b32 s71, 4, 0
    s_sub_u32 s32, s32, s71
    s_add_u32 s33, s53, 1
    s_cmp_ge_u32 s33, 4
    s_cselect_b32 s71, 4, 0
    s_sub_u32 s33, s33, s71
    s_add_u32 s34, s53, 2
    s_cmp_ge_u32 s34, 4
    s_cselect_b32 s71, 4, 0
    s_sub_u32 s34, s34, s71
    s_add_u32 s35, s53, 3
    s_cmp_ge_u32 s35, 4
    s_cselect_b32 s71, 4, 0
    s_sub_u32 s35, s35, s71
    s_add_u32 s36, s53, 0
    s_cmp_ge_u32 s36, 3
    s_cselect_b32 s71, 3, 0
    s_sub_u32 s36, s36, s71
    s_add_u32 s36, s36, 4
    s_add_u32 s37, s53, 1
    s_cmp_ge_u32 s37, 3
    s_cselect_b32 s71, 3, 0
    s_sub_u32 s37, s37, s71
    s_add_u32 s37, s37, 4
    s_add_u32 s38, s53, 2
    s_cmp_ge_u32 s38, 3
    s_cselect_b32 s71, 3, 0
    s_sub_u32 s38, s38, s71
    s_add_u32 s38, s38, 4
    s_lshl1_add_u32 s69, s62, s49
    s_lshl_b32 s71, s69, 10
    s_add_u32 s71, s71, 14680064
    s_lshl1_add_u32 s70, s61, s48
    s_lshl_b32 s73, s70, 9
    s_add_u32 s73, s73, 14745600
    s_mul_i32 s74, s70, 230400
    s_lshl_b32 s72, s69, 13
    s_add_u32 s74, s74, s72
    s_lshl4_add_u32 s75, s61, s62
    s_lshl_b32 s75, s75, 7
    s_add_u32 s75, s75, 14876672
    s_mov_b32 s54, 0x3f803f80
    v_mov_b32 v212, 0
    v_mov_b32 v213, 0
    v_mov_b32 v214, 0
    v_mov_b32 v215, 0
    v_mov_b32 v216, 0
    v_mov_b32 v217, 0
    v_mov_b32 v218, 0
    v_mov_b32 v219, 0
    s_waitcnt lgkmcnt(0)
    s_barrier
    ds_read_b128 v[164:167], v236 offset:0
    ds_read_b128 v[168:171], v236 offset:2048
    ds_read_b128 v[172:175], v236 offset:4096
    ds_read_b128 v[176:179], v236 offset:6144
    ds_read_b64_tr_b16 v[132:133], v248 offset:49152
    ds_read_b64_tr_b16 v[134:135], v248 offset:50176
    ds_read_b64_tr_b16 v[136:137], v248 offset:57344
    ds_read_b64_tr_b16 v[138:139], v248 offset:58368
    ds_read_b64_tr_b16 v[140:141], v249 offset:49152
    ds_read_b64_tr_b16 v[142:143], v249 offset:50176
    ds_read_b64_tr_b16 v[144:145], v249 offset:57344
    ds_read_b64_tr_b16 v[146:147], v249 offset:58368
    ds_read_b64_tr_b16 v[148:149], v250 offset:49152
    ds_read_b64_tr_b16 v[150:151], v250 offset:50176
    ds_read_b64_tr_b16 v[152:153], v250 offset:57344
    ds_read_b64_tr_b16 v[154:155], v250 offset:58368
    ds_read_b64_tr_b16 v[156:157], v251 offset:49152
    ds_read_b64_tr_b16 v[158:159], v251 offset:50176
    ds_read_b64_tr_b16 v[160:161], v251 offset:57344
    ds_read_b64_tr_b16 v[162:163], v251 offset:58368
    buffer_load_dword v238, off, s[28:31], 0 sc1
    s_waitcnt lgkmcnt(12)
    v_mfma_f32_16x16x32_bf16 v[4:7], v[132:135], v[164:167], 0
    v_mfma_f32_16x16x32_bf16 v[8:11], v[132:135], v[168:171], 0
    v_dot2c_f32_bf16 v212, s54, v132
    v_dot2c_f32_bf16 v212, s54, v133
    v_dot2c_f32_bf16 v212, s54, v134
    v_dot2c_f32_bf16 v212, s54, v135
    v_mfma_f32_16x16x32_bf16 v[12:15], v[132:135], v[172:175], 0
    v_mfma_f32_16x16x32_bf16 v[16:19], v[132:135], v[176:179], 0
    v_mfma_f32_16x16x32_bf16 v[68:71], v[136:139], v[164:167], 0
    v_mfma_f32_16x16x32_bf16 v[72:75], v[136:139], v[168:171], 0
    v_dot2c_f32_bf16 v216, s54, v136
    v_dot2c_f32_bf16 v216, s54, v137
    v_dot2c_f32_bf16 v216, s54, v138
    v_dot2c_f32_bf16 v216, s54, v139
    v_mfma_f32_16x16x32_bf16 v[76:79], v[136:139], v[172:175], 0
    v_mfma_f32_16x16x32_bf16 v[80:83], v[136:139], v[176:179], 0
    s_waitcnt lgkmcnt(0)
    s_barrier
    ds_read_b64_tr_b16 v[132:133], v252 offset:16384
    v_mfma_f32_16x16x32_bf16 v[20:23], v[140:143], v[164:167], 0
    ds_read_b64_tr_b16 v[134:135], v252 offset:17408
    v_mfma_f32_16x16x32_bf16 v[24:27], v[140:143], v[168:171], 0
    v_dot2c_f32_bf16 v213, s54, v140
    v_dot2c_f32_bf16 v213, s54, v141
    v_dot2c_f32_bf16 v213, s54, v142
    v_dot2c_f32_bf16 v213, s54, v143
    ds_read_b64_tr_b16 v[136:137], v252 offset:24576
    v_mfma_f32_16x16x32_bf16 v[28:31], v[140:143], v[172:175], 0
    ds_read_b64_tr_b16 v[138:139], v252 offset:25600
    v_mfma_f32_16x16x32_bf16 v[32:35], v[140:143], v[176:179], 0
    ds_read_b128 v[180:183], v237 offset:0
    v_mfma_f32_16x16x32_bf16 v[84:87], v[144:147], v[164:167], 0
    ds_read_b128 v[184:187], v237 offset:2048
    v_mfma_f32_16x16x32_bf16 v[88:91], v[144:147], v[168:171], 0
    v_dot2c_f32_bf16 v217, s54, v144
    v_dot2c_f32_bf16 v217, s54, v145
    v_dot2c_f32_bf16 v217, s54, v146
    v_dot2c_f32_bf16 v217, s54, v147
    ds_read_b128 v[188:191], v237 offset:4096
    v_mfma_f32_16x16x32_bf16 v[92:95], v[144:147], v[172:175], 0
    ds_read_b128 v[192:195], v237 offset:6144
    v_mfma_f32_16x16x32_bf16 v[96:99], v[144:147], v[176:179], 0
    ds_read_b64_tr_b16 v[140:141], v253 offset:16384
    v_mfma_f32_16x16x32_bf16 v[36:39], v[148:151], v[164:167], 0
    ds_read_b64_tr_b16 v[142:143], v253 offset:17408
    v_mfma_f32_16x16x32_bf16 v[40:43], v[148:151], v[168:171], 0
    v_dot2c_f32_bf16 v214, s54, v148
    v_dot2c_f32_bf16 v214, s54, v149
    v_dot2c_f32_bf16 v214, s54, v150
    v_dot2c_f32_bf16 v214, s54, v151
    ds_read_b64_tr_b16 v[144:145], v253 offset:24576
    v_mfma_f32_16x16x32_bf16 v[44:47], v[148:151], v[172:175], 0
    ds_read_b64_tr_b16 v[146:147], v253 offset:25600
    v_mfma_f32_16x16x32_bf16 v[48:51], v[148:151], v[176:179], 0
    ds_read_b64_tr_b16 v[148:149], v254 offset:16384
    v_mfma_f32_16x16x32_bf16 v[100:103], v[152:155], v[164:167], 0
    ds_read_b64_tr_b16 v[150:151], v254 offset:17408
    v_mfma_f32_16x16x32_bf16 v[104:107], v[152:155], v[168:171], 0
    v_dot2c_f32_bf16 v218, s54, v152
    v_dot2c_f32_bf16 v218, s54, v153
    v_dot2c_f32_bf16 v218, s54, v154
    v_dot2c_f32_bf16 v218, s54, v155
    v_mfma_f32_16x16x32_bf16 v[108:111], v[152:155], v[172:175], 0
    v_mfma_f32_16x16x32_bf16 v[112:115], v[152:155], v[176:179], 0
    ds_read_b64_tr_b16 v[152:153], v254 offset:24576
    v_mfma_f32_16x16x32_bf16 v[52:55], v[156:159], v[164:167], 0
    ds_read_b64_tr_b16 v[154:155], v254 offset:25600
    v_mfma_f32_16x16x32_bf16 v[56:59], v[156:159], v[168:171], 0
    v_dot2c_f32_bf16 v215, s54, v156
    v_dot2c_f32_bf16 v215, s54, v157
    v_dot2c_f32_bf16 v215, s54, v158
    v_dot2c_f32_bf16 v215, s54, v159
    v_mfma_f32_16x16x32_bf16 v[60:63], v[156:159], v[172:175], 0
    v_mfma_f32_16x16x32_bf16 v[64:67], v[156:159], v[176:179], 0
    ds_read_b64_tr_b16 v[156:157], v255 offset:16384
    v_mfma_f32_16x16x32_bf16 v[116:119], v[160:163], v[164:167], 0
    ds_read_b64_tr_b16 v[158:159], v255 offset:17408
    v_mfma_f32_16x16x32_bf16 v[120:123], v[160:163], v[168:171], 0
    v_dot2c_f32_bf16 v219, s54, v160
    v_dot2c_f32_bf16 v219, s54, v161
    v_dot2c_f32_bf16 v219, s54, v162
    v_dot2c_f32_bf16 v219, s54, v163
    v_mfma_f32_16x16x32_bf16 v[124:127], v[160:163], v[172:175], 0
    v_mfma_f32_16x16x32_bf16 v[128:131], v[160:163], v[176:179], 0
    ds_read_b64_tr_b16 v[160:161], v255 offset:24576
    s_waitcnt lgkmcnt(11)
    v_mfma_f32_16x16x32_bf16 v[4:7], v[132:135], v[180:183], v[4:7]
    ds_read_b64_tr_b16 v[162:163], v255 offset:25600
    v_mfma_f32_16x16x32_bf16 v[8:11], v[132:135], v[184:187], v[8:11]
    v_dot2c_f32_bf16 v212, s54, v132
    v_dot2c_f32_bf16 v212, s54, v133
    v_dot2c_f32_bf16 v212, s54, v134
    v_dot2c_f32_bf16 v212, s54, v135
    v_mfma_f32_16x16x32_bf16 v[12:15], v[132:135], v[188:191], v[12:15]
    v_mfma_f32_16x16x32_bf16 v[16:19], v[132:135], v[192:195], v[16:19]
    v_mfma_f32_16x16x32_bf16 v[68:71], v[136:139], v[180:183], v[68:71]
    v_mfma_f32_16x16x32_bf16 v[72:75], v[136:139], v[184:187], v[72:75]
    v_dot2c_f32_bf16 v216, s54, v136
    v_dot2c_f32_bf16 v216, s54, v137
    v_dot2c_f32_bf16 v216, s54, v138
    v_dot2c_f32_bf16 v216, s54, v139
    v_mfma_f32_16x16x32_bf16 v[76:79], v[136:139], v[188:191], v[76:79]
    v_mfma_f32_16x16x32_bf16 v[80:83], v[136:139], v[192:195], v[80:83]
    s_waitcnt lgkmcnt(0)
    s_barrier
    ds_read_b64_tr_b16 v[132:133], v252 offset:32768
    v_mfma_f32_16x16x32_bf16 v[20:23], v[140:143], v[180:183], v[20:23]
    ds_read_b64_tr_b16 v[134:135], v252 offset:33792
    v_mfma_f32_16x16x32_bf16 v[24:27], v[140:143], v[184:187], v[24:27]
    v_dot2c_f32_bf16 v213, s54, v140
    v_dot2c_f32_bf16 v213, s54, v141
    v_dot2c_f32_bf16 v213, s54, v142
    v_dot2c_f32_bf16 v213, s54, v143
    ds_read_b64_tr_b16 v[136:137], v252 offset:40960
    v_mfma_f32_16x16x32_bf16 v[28:31], v[140:143], v[188:191], v[28:31]
    ds_read_b64_tr_b16 v[138:139], v252 offset:41984
    v_mfma_f32_16x16x32_bf16 v[32:35], v[140:143], v[192:195], v[32:35]
    ds_read_b128 v[164:167], v236 offset:49152
    v_mfma_f32_16x16x32_bf16 v[84:87], v[144:147], v[180:183], v[84:87]
    ds_read_b128 v[168:171], v236 offset:51200
    v_mfma_f32_16x16x32_bf16 v[88:91], v[144:147], v[184:187], v[88:91]
    v_dot2c_f32_bf16 v217, s54, v144
    v_dot2c_f32_bf16 v217, s54, v145
    v_dot2c_f32_bf16 v217, s54, v146
    v_dot2c_f32_bf16 v217, s54, v147
    ds_read_b128 v[172:175], v236 offset:53248
    v_mfma_f32_16x16x32_bf16 v[92:95], v[144:147], v[188:191], v[92:95]
    ds_read_b128 v[176:179], v236 offset:55296
    v_mfma_f32_16x16x32_bf16 v[96:99], v[144:147], v[192:195], v[96:99]
    ds_read_b64_tr_b16 v[140:141], v253 offset:32768
    v_mfma_f32_16x16x32_bf16 v[36:39], v[148:151], v[180:183], v[36:39]
    ds_read_b64_tr_b16 v[142:143], v253 offset:33792
    v_mfma_f32_16x16x32_bf16 v[40:43], v[148:151], v[184:187], v[40:43]
    v_dot2c_f32_bf16 v214, s54, v148
    v_dot2c_f32_bf16 v214, s54, v149
    v_dot2c_f32_bf16 v214, s54, v150
    v_dot2c_f32_bf16 v214, s54, v151
    ds_read_b64_tr_b16 v[144:145], v253 offset:40960
    v_mfma_f32_16x16x32_bf16 v[44:47], v[148:151], v[188:191], v[44:47]
    ds_read_b64_tr_b16 v[146:147], v253 offset:41984
    v_mfma_f32_16x16x32_bf16 v[48:51], v[148:151], v[192:195], v[48:51]
    ds_read_b64_tr_b16 v[148:149], v254 offset:32768
    v_mfma_f32_16x16x32_bf16 v[100:103], v[152:155], v[180:183], v[100:103]
    ds_read_b64_tr_b16 v[150:151], v254 offset:33792
    v_mfma_f32_16x16x32_bf16 v[104:107], v[152:155], v[184:187], v[104:107]
    v_dot2c_f32_bf16 v218, s54, v152
    v_dot2c_f32_bf16 v218, s54, v153
    v_dot2c_f32_bf16 v218, s54, v154
    v_dot2c_f32_bf16 v218, s54, v155
    v_mfma_f32_16x16x32_bf16 v[108:111], v[152:155], v[188:191], v[108:111]
    v_mfma_f32_16x16x32_bf16 v[112:115], v[152:155], v[192:195], v[112:115]
    ds_read_b64_tr_b16 v[152:153], v254 offset:40960
    v_mfma_f32_16x16x32_bf16 v[52:55], v[156:159], v[180:183], v[52:55]
    ds_read_b64_tr_b16 v[154:155], v254 offset:41984
    v_mfma_f32_16x16x32_bf16 v[56:59], v[156:159], v[184:187], v[56:59]
    v_dot2c_f32_bf16 v215, s54, v156
    v_dot2c_f32_bf16 v215, s54, v157
    v_dot2c_f32_bf16 v215, s54, v158
    v_dot2c_f32_bf16 v215, s54, v159
    v_mfma_f32_16x16x32_bf16 v[60:63], v[156:159], v[188:191], v[60:63]
    v_mfma_f32_16x16x32_bf16 v[64:67], v[156:159], v[192:195], v[64:67]
    ds_read_b64_tr_b16 v[156:157], v255 offset:32768
    v_mfma_f32_16x16x32_bf16 v[116:119], v[160:163], v[180:183], v[116:119]
    ds_read_b64_tr_b16 v[158:159], v255 offset:33792
    v_mfma_f32_16x16x32_bf16 v[120:123], v[160:163], v[184:187], v[120:123]
    v_dot2c_f32_bf16 v219, s54, v160
    v_dot2c_f32_bf16 v219, s54, v161
    v_dot2c_f32_bf16 v219, s54, v162
    v_dot2c_f32_bf16 v219, s54, v163
    v_mfma_f32_16x16x32_bf16 v[124:127], v[160:163], v[188:191], v[124:127]
    v_mfma_f32_16x16x32_bf16 v[128:131], v[160:163], v[192:195], v[128:131]
    ds_read_b64_tr_b16 v[160:161], v255 offset:40960
    s_waitcnt lgkmcnt(11)
    v_mfma_f32_16x16x32_bf16 v[4:7], v[132:135], v[164:167], v[4:7]
    ds_read_b64_tr_b16 v[162:163], v255 offset:41984
    v_mfma_f32_16x16x32_bf16 v[8:11], v[132:135], v[168:171], v[8:11]
    v_dot2c_f32_bf16 v212, s54, v132
    v_dot2c_f32_bf16 v212, s54, v133
    v_dot2c_f32_bf16 v212, s54, v134
    v_dot2c_f32_bf16 v212, s54, v135
    v_mfma_f32_16x16x32_bf16 v[12:15], v[132:135], v[172:175], v[12:15]
    v_mfma_f32_16x16x32_bf16 v[16:19], v[132:135], v[176:179], v[16:19]
    v_mfma_f32_16x16x32_bf16 v[68:71], v[136:139], v[164:167], v[68:71]
    v_mfma_f32_16x16x32_bf16 v[72:75], v[136:139], v[168:171], v[72:75]
    v_dot2c_f32_bf16 v216, s54, v136
    v_dot2c_f32_bf16 v216, s54, v137
    v_dot2c_f32_bf16 v216, s54, v138
    v_dot2c_f32_bf16 v216, s54, v139
    v_mfma_f32_16x16x32_bf16 v[76:79], v[136:139], v[172:175], v[76:79]
    v_mfma_f32_16x16x32_bf16 v[80:83], v[136:139], v[176:179], v[80:83]
    s_waitcnt lgkmcnt(0)
    s_barrier
    ds_read_b64_tr_b16 v[132:133], v248 offset:0
    v_mfma_f32_16x16x32_bf16 v[20:23], v[140:143], v[164:167], v[20:23]
    ds_read_b64_tr_b16 v[134:135], v248 offset:1024
    v_mfma_f32_16x16x32_bf16 v[24:27], v[140:143], v[168:171], v[24:27]
    v_dot2c_f32_bf16 v213, s54, v140
    v_dot2c_f32_bf16 v213, s54, v141
    v_dot2c_f32_bf16 v213, s54, v142
    v_dot2c_f32_bf16 v213, s54, v143
    ds_read_b64_tr_b16 v[136:137], v248 offset:8192
    v_mfma_f32_16x16x32_bf16 v[28:31], v[140:143], v[172:175], v[28:31]
    ds_read_b64_tr_b16 v[138:139], v248 offset:9216
    v_mfma_f32_16x16x32_bf16 v[32:35], v[140:143], v[176:179], v[32:35]
    ds_read_b128 v[180:183], v237 offset:49152
    v_mfma_f32_16x16x32_bf16 v[84:87], v[144:147], v[164:167], v[84:87]
    ds_read_b128 v[184:187], v237 offset:51200
    v_mfma_f32_16x16x32_bf16 v[88:91], v[144:147], v[168:171], v[88:91]
    v_dot2c_f32_bf16 v217, s54, v144
    v_dot2c_f32_bf16 v217, s54, v145
    v_dot2c_f32_bf16 v217, s54, v146
    v_dot2c_f32_bf16 v217, s54, v147
    ds_read_b128 v[188:191], v237 offset:53248
    v_mfma_f32_16x16x32_bf16 v[92:95], v[144:147], v[172:175], v[92:95]
    ds_read_b128 v[192:195], v237 offset:55296
    v_mfma_f32_16x16x32_bf16 v[96:99], v[144:147], v[176:179], v[96:99]
    ds_read_b64_tr_b16 v[140:141], v249 offset:0
    v_mfma_f32_16x16x32_bf16 v[36:39], v[148:151], v[164:167], v[36:39]
    ds_read_b64_tr_b16 v[142:143], v249 offset:1024
    v_mfma_f32_16x16x32_bf16 v[40:43], v[148:151], v[168:171], v[40:43]
    v_dot2c_f32_bf16 v214, s54, v148
    v_dot2c_f32_bf16 v214, s54, v149
    v_dot2c_f32_bf16 v214, s54, v150
    v_dot2c_f32_bf16 v214, s54, v151
    ds_read_b64_tr_b16 v[144:145], v249 offset:8192
    v_mfma_f32_16x16x32_bf16 v[44:47], v[148:151], v[172:175], v[44:47]
    ds_read_b64_tr_b16 v[146:147], v249 offset:9216
    v_mfma_f32_16x16x32_bf16 v[48:51], v[148:151], v[176:179], v[48:51]
    ds_read_b64_tr_b16 v[148:149], v250 offset:0
    v_mfma_f32_16x16x32_bf16 v[100:103], v[152:155], v[164:167], v[100:103]
    ds_read_b64_tr_b16 v[150:151], v250 offset:1024
    v_mfma_f32_16x16x32_bf16 v[104:107], v[152:155], v[168:171], v[104:107]
    v_dot2c_f32_bf16 v218, s54, v152
    v_dot2c_f32_bf16 v218, s54, v153
    v_dot2c_f32_bf16 v218, s54, v154
    v_dot2c_f32_bf16 v218, s54, v155
    v_mfma_f32_16x16x32_bf16 v[108:111], v[152:155], v[172:175], v[108:111]
    v_mfma_f32_16x16x32_bf16 v[112:115], v[152:155], v[176:179], v[112:115]
    ds_read_b64_tr_b16 v[152:153], v250 offset:8192
    v_mfma_f32_16x16x32_bf16 v[52:55], v[156:159], v[164:167], v[52:55]
    ds_read_b64_tr_b16 v[154:155], v250 offset:9216
    v_mfma_f32_16x16x32_bf16 v[56:59], v[156:159], v[168:171], v[56:59]
    v_dot2c_f32_bf16 v215, s54, v156
    v_dot2c_f32_bf16 v215, s54, v157
    v_dot2c_f32_bf16 v215, s54, v158
    v_dot2c_f32_bf16 v215, s54, v159
    v_mfma_f32_16x16x32_bf16 v[60:63], v[156:159], v[172:175], v[60:63]
    v_mfma_f32_16x16x32_bf16 v[64:67], v[156:159], v[176:179], v[64:67]
    ds_read_b64_tr_b16 v[156:157], v251 offset:0
    v_mfma_f32_16x16x32_bf16 v[116:119], v[160:163], v[164:167], v[116:119]
    ds_read_b64_tr_b16 v[158:159], v251 offset:1024
    v_mfma_f32_16x16x32_bf16 v[120:123], v[160:163], v[168:171], v[120:123]
    v_dot2c_f32_bf16 v219, s54, v160
    v_dot2c_f32_bf16 v219, s54, v161
    v_dot2c_f32_bf16 v219, s54, v162
    v_dot2c_f32_bf16 v219, s54, v163
    v_mfma_f32_16x16x32_bf16 v[124:127], v[160:163], v[172:175], v[124:127]
    v_mfma_f32_16x16x32_bf16 v[128:131], v[160:163], v[176:179], v[128:131]
    ds_read_b64_tr_b16 v[160:161], v251 offset:8192
    s_waitcnt lgkmcnt(11)
    v_mfma_f32_16x16x32_bf16 v[4:7], v[132:135], v[180:183], v[4:7]
    ds_read_b64_tr_b16 v[162:163], v251 offset:9216
    v_mfma_f32_16x16x32_bf16 v[8:11], v[132:135], v[184:187], v[8:11]
    v_dot2c_f32_bf16 v212, s54, v132
    v_dot2c_f32_bf16 v212, s54, v133
    v_dot2c_f32_bf16 v212, s54, v134
    v_dot2c_f32_bf16 v212, s54, v135
    v_mfma_f32_16x16x32_bf16 v[12:15], v[132:135], v[188:191], v[12:15]
    v_mfma_f32_16x16x32_bf16 v[16:19], v[132:135], v[192:195], v[16:19]
    v_mfma_f32_16x16x32_bf16 v[68:71], v[136:139], v[180:183], v[68:71]
    v_mfma_f32_16x16x32_bf16 v[72:75], v[136:139], v[184:187], v[72:75]
    v_dot2c_f32_bf16 v216, s54, v136
    v_dot2c_f32_bf16 v216, s54, v137
    v_dot2c_f32_bf16 v216, s54, v138
    v_dot2c_f32_bf16 v216, s54, v139
    v_mfma_f32_16x16x32_bf16 v[76:79], v[136:139], v[188:191], v[76:79]
    v_mfma_f32_16x16x32_bf16 v[80:83], v[136:139], v[192:195], v[80:83]
    s_waitcnt lgkmcnt(0)
    s_barrier
    ds_read_b64_tr_b16 v[132:133], v248 offset:16384
    v_mfma_f32_16x16x32_bf16 v[20:23], v[140:143], v[180:183], v[20:23]
    ds_read_b64_tr_b16 v[134:135], v248 offset:17408
    v_mfma_f32_16x16x32_bf16 v[24:27], v[140:143], v[184:187], v[24:27]
    v_dot2c_f32_bf16 v213, s54, v140
    v_dot2c_f32_bf16 v213, s54, v141
    v_dot2c_f32_bf16 v213, s54, v142
    v_dot2c_f32_bf16 v213, s54, v143
    ds_read_b64_tr_b16 v[136:137], v248 offset:24576
    v_mfma_f32_16x16x32_bf16 v[28:31], v[140:143], v[188:191], v[28:31]
    ds_read_b64_tr_b16 v[138:139], v248 offset:25600
    v_mfma_f32_16x16x32_bf16 v[32:35], v[140:143], v[192:195], v[32:35]
    ds_read_b128 v[164:167], v234 offset:32768
    v_mfma_f32_16x16x32_bf16 v[84:87], v[144:147], v[180:183], v[84:87]
    ds_read_b128 v[168:171], v234 offset:34816
    v_mfma_f32_16x16x32_bf16 v[88:91], v[144:147], v[184:187], v[88:91]
    v_dot2c_f32_bf16 v217, s54, v144
    v_dot2c_f32_bf16 v217, s54, v145
    v_dot2c_f32_bf16 v217, s54, v146
    v_dot2c_f32_bf16 v217, s54, v147
    ds_read_b128 v[172:175], v234 offset:36864
    v_mfma_f32_16x16x32_bf16 v[92:95], v[144:147], v[188:191], v[92:95]
    ds_read_b128 v[176:179], v234 offset:38912
    v_mfma_f32_16x16x32_bf16 v[96:99], v[144:147], v[192:195], v[96:99]
    ds_read_b64_tr_b16 v[140:141], v249 offset:16384
    v_mfma_f32_16x16x32_bf16 v[36:39], v[148:151], v[180:183], v[36:39]
    ds_read_b64_tr_b16 v[142:143], v249 offset:17408
    v_mfma_f32_16x16x32_bf16 v[40:43], v[148:151], v[184:187], v[40:43]
    v_dot2c_f32_bf16 v214, s54, v148
    v_dot2c_f32_bf16 v214, s54, v149
    v_dot2c_f32_bf16 v214, s54, v150
    v_dot2c_f32_bf16 v214, s54, v151
    ds_read_b64_tr_b16 v[144:145], v249 offset:24576
    v_mfma_f32_16x16x32_bf16 v[44:47], v[148:151], v[188:191], v[44:47]
    ds_read_b64_tr_b16 v[146:147], v249 offset:25600
    v_mfma_f32_16x16x32_bf16 v[48:51], v[148:151], v[192:195], v[48:51]
    ds_read_b64_tr_b16 v[148:149], v250 offset:16384
    v_mfma_f32_16x16x32_bf16 v[100:103], v[152:155], v[180:183], v[100:103]
    ds_read_b64_tr_b16 v[150:151], v250 offset:17408
    v_mfma_f32_16x16x32_bf16 v[104:107], v[152:155], v[184:187], v[104:107]
    v_dot2c_f32_bf16 v218, s54, v152
    v_dot2c_f32_bf16 v218, s54, v153
    v_dot2c_f32_bf16 v218, s54, v154
    v_dot2c_f32_bf16 v218, s54, v155
    v_mfma_f32_16x16x32_bf16 v[108:111], v[152:155], v[188:191], v[108:111]
    v_mfma_f32_16x16x32_bf16 v[112:115], v[152:155], v[192:195], v[112:115]
    ds_read_b64_tr_b16 v[152:153], v250 offset:24576
    v_mfma_f32_16x16x32_bf16 v[52:55], v[156:159], v[180:183], v[52:55]
    ds_read_b64_tr_b16 v[154:155], v250 offset:25600
    v_mfma_f32_16x16x32_bf16 v[56:59], v[156:159], v[184:187], v[56:59]
    v_dot2c_f32_bf16 v215, s54, v156
    v_dot2c_f32_bf16 v215, s54, v157
    v_dot2c_f32_bf16 v215, s54, v158
    v_dot2c_f32_bf16 v215, s54, v159
    v_mfma_f32_16x16x32_bf16 v[60:63], v[156:159], v[188:191], v[60:63]
    v_mfma_f32_16x16x32_bf16 v[64:67], v[156:159], v[192:195], v[64:67]
    ds_read_b64_tr_b16 v[156:157], v251 offset:16384
    v_mfma_f32_16x16x32_bf16 v[116:119], v[160:163], v[180:183], v[116:119]
    ds_read_b64_tr_b16 v[158:159], v251 offset:17408
    v_mfma_f32_16x16x32_bf16 v[120:123], v[160:163], v[184:187], v[120:123]
    v_dot2c_f32_bf16 v219, s54, v160
    v_dot2c_f32_bf16 v219, s54, v161
    v_dot2c_f32_bf16 v219, s54, v162
    v_dot2c_f32_bf16 v219, s54, v163
    v_mfma_f32_16x16x32_bf16 v[124:127], v[160:163], v[188:191], v[124:127]
    v_mfma_f32_16x16x32_bf16 v[128:131], v[160:163], v[192:195], v[128:131]
    ds_read_b64_tr_b16 v[160:161], v251 offset:24576
    s_waitcnt lgkmcnt(11)
    v_mfma_f32_16x16x32_bf16 v[4:7], v[132:135], v[164:167], v[4:7]
    ds_read_b64_tr_b16 v[162:163], v251 offset:25600
    v_mfma_f32_16x16x32_bf16 v[8:11], v[132:135], v[168:171], v[8:11]
    v_dot2c_f32_bf16 v212, s54, v132
    v_dot2c_f32_bf16 v212, s54, v133
    v_dot2c_f32_bf16 v212, s54, v134
    v_dot2c_f32_bf16 v212, s54, v135
    v_mfma_f32_16x16x32_bf16 v[12:15], v[132:135], v[172:175], v[12:15]
    v_mfma_f32_16x16x32_bf16 v[16:19], v[132:135], v[176:179], v[16:19]
    v_mfma_f32_16x16x32_bf16 v[68:71], v[136:139], v[164:167], v[68:71]
    v_mfma_f32_16x16x32_bf16 v[72:75], v[136:139], v[168:171], v[72:75]
    v_dot2c_f32_bf16 v216, s54, v136
    v_dot2c_f32_bf16 v216, s54, v137
    v_dot2c_f32_bf16 v216, s54, v138
    v_dot2c_f32_bf16 v216, s54, v139
    v_mfma_f32_16x16x32_bf16 v[76:79], v[136:139], v[172:175], v[76:79]
    v_mfma_f32_16x16x32_bf16 v[80:83], v[136:139], v[176:179], v[80:83]
    s_waitcnt lgkmcnt(0)
    s_barrier
    ds_read_b64_tr_b16 v[132:133], v248 offset:49152
    v_mfma_f32_16x16x32_bf16 v[20:23], v[140:143], v[164:167], v[20:23]
    ds_read_b64_tr_b16 v[134:135], v248 offset:50176
    v_mfma_f32_16x16x32_bf16 v[24:27], v[140:143], v[168:171], v[24:27]
    v_dot2c_f32_bf16 v213, s54, v140
    v_dot2c_f32_bf16 v213, s54, v141
    v_dot2c_f32_bf16 v213, s54, v142
    v_dot2c_f32_bf16 v213, s54, v143
    ds_read_b64_tr_b16 v[136:137], v248 offset:57344
    v_mfma_f32_16x16x32_bf16 v[28:31], v[140:143], v[172:175], v[28:31]
    ds_read_b64_tr_b16 v[138:139], v248 offset:58368
    v_mfma_f32_16x16x32_bf16 v[32:35], v[140:143], v[176:179], v[32:35]
    ds_read_b128 v[180:183], v235 offset:32768
    v_mfma_f32_16x16x32_bf16 v[84:87], v[144:147], v[164:167], v[84:87]
    ds_read_b128 v[184:187], v235 offset:34816
    v_mfma_f32_16x16x32_bf16 v[88:91], v[144:147], v[168:171], v[88:91]
    v_dot2c_f32_bf16 v217, s54, v144
    v_dot2c_f32_bf16 v217, s54, v145
    v_dot2c_f32_bf16 v217, s54, v146
    v_dot2c_f32_bf16 v217, s54, v147
    ds_read_b128 v[188:191], v235 offset:36864
    v_mfma_f32_16x16x32_bf16 v[92:95], v[144:147], v[172:175], v[92:95]
    ds_read_b128 v[192:195], v235 offset:38912
    v_mfma_f32_16x16x32_bf16 v[96:99], v[144:147], v[176:179], v[96:99]
    ds_read_b64_tr_b16 v[140:141], v249 offset:49152
    v_mfma_f32_16x16x32_bf16 v[36:39], v[148:151], v[164:167], v[36:39]
    ds_read_b64_tr_b16 v[142:143], v249 offset:50176
    v_mfma_f32_16x16x32_bf16 v[40:43], v[148:151], v[168:171], v[40:43]
    v_dot2c_f32_bf16 v214, s54, v148
    v_dot2c_f32_bf16 v214, s54, v149
    v_dot2c_f32_bf16 v214, s54, v150
    v_dot2c_f32_bf16 v214, s54, v151
    ds_read_b64_tr_b16 v[144:145], v249 offset:57344
    v_mfma_f32_16x16x32_bf16 v[44:47], v[148:151], v[172:175], v[44:47]
    ds_read_b64_tr_b16 v[146:147], v249 offset:58368
    v_mfma_f32_16x16x32_bf16 v[48:51], v[148:151], v[176:179], v[48:51]
    ds_read_b64_tr_b16 v[148:149], v250 offset:49152
    v_mfma_f32_16x16x32_bf16 v[100:103], v[152:155], v[164:167], v[100:103]
    ds_read_b64_tr_b16 v[150:151], v250 offset:50176
    v_mfma_f32_16x16x32_bf16 v[104:107], v[152:155], v[168:171], v[104:107]
    v_dot2c_f32_bf16 v218, s54, v152
    v_dot2c_f32_bf16 v218, s54, v153
    v_dot2c_f32_bf16 v218, s54, v154
    v_dot2c_f32_bf16 v218, s54, v155
    v_mfma_f32_16x16x32_bf16 v[108:111], v[152:155], v[172:175], v[108:111]
    v_mfma_f32_16x16x32_bf16 v[112:115], v[152:155], v[176:179], v[112:115]
    ds_read_b64_tr_b16 v[152:153], v250 offset:57344
    v_mfma_f32_16x16x32_bf16 v[52:55], v[156:159], v[164:167], v[52:55]
    ds_read_b64_tr_b16 v[154:155], v250 offset:58368
    v_mfma_f32_16x16x32_bf16 v[56:59], v[156:159], v[168:171], v[56:59]
    v_dot2c_f32_bf16 v215, s54, v156
    v_dot2c_f32_bf16 v215, s54, v157
    v_dot2c_f32_bf16 v215, s54, v158
    v_dot2c_f32_bf16 v215, s54, v159
    v_mfma_f32_16x16x32_bf16 v[60:63], v[156:159], v[172:175], v[60:63]
    v_mfma_f32_16x16x32_bf16 v[64:67], v[156:159], v[176:179], v[64:67]
    ds_read_b64_tr_b16 v[156:157], v251 offset:49152
    v_mfma_f32_16x16x32_bf16 v[116:119], v[160:163], v[164:167], v[116:119]
    ds_read_b64_tr_b16 v[158:159], v251 offset:50176
    v_mfma_f32_16x16x32_bf16 v[120:123], v[160:163], v[168:171], v[120:123]
    v_dot2c_f32_bf16 v219, s54, v160
    v_dot2c_f32_bf16 v219, s54, v161
    v_dot2c_f32_bf16 v219, s54, v162
    v_dot2c_f32_bf16 v219, s54, v163
    v_mfma_f32_16x16x32_bf16 v[124:127], v[160:163], v[172:175], v[124:127]
    v_mfma_f32_16x16x32_bf16 v[128:131], v[160:163], v[176:179], v[128:131]
    ds_read_b64_tr_b16 v[160:161], v251 offset:57344
    s_waitcnt lgkmcnt(11)
    v_mfma_f32_16x16x32_bf16 v[4:7], v[132:135], v[180:183], v[4:7]
    ds_read_b64_tr_b16 v[162:163], v251 offset:58368
    v_mfma_f32_16x16x32_bf16 v[8:11], v[132:135], v[184:187], v[8:11]
    v_dot2c_f32_bf16 v212, s54, v132
    v_dot2c_f32_bf16 v212, s54, v133
    v_dot2c_f32_bf16 v212, s54, v134
    v_dot2c_f32_bf16 v212, s54, v135
    v_mfma_f32_16x16x32_bf16 v[12:15], v[132:135], v[188:191], v[12:15]
    v_mfma_f32_16x16x32_bf16 v[16:19], v[132:135], v[192:195], v[16:19]
    v_mfma_f32_16x16x32_bf16 v[68:71], v[136:139], v[180:183], v[68:71]
    v_mfma_f32_16x16x32_bf16 v[72:75], v[136:139], v[184:187], v[72:75]
    v_dot2c_f32_bf16 v216, s54, v136
    v_dot2c_f32_bf16 v216, s54, v137
    v_dot2c_f32_bf16 v216, s54, v138
    v_dot2c_f32_bf16 v216, s54, v139
    v_mfma_f32_16x16x32_bf16 v[76:79], v[136:139], v[188:191], v[76:79]
    v_mfma_f32_16x16x32_bf16 v[80:83], v[136:139], v[192:195], v[80:83]
    s_waitcnt lgkmcnt(0)
    s_barrier
    ds_read_b64_tr_b16 v[132:133], v252 offset:0
    v_mfma_f32_16x16x32_bf16 v[20:23], v[140:143], v[180:183], v[20:23]
    ds_read_b64_tr_b16 v[134:135], v252 offset:1024
    v_mfma_f32_16x16x32_bf16 v[24:27], v[140:143], v[184:187], v[24:27]
    v_dot2c_f32_bf16 v213, s54, v140
    v_dot2c_f32_bf16 v213, s54, v141
    v_dot2c_f32_bf16 v213, s54, v142
    v_dot2c_f32_bf16 v213, s54, v143
    ds_read_b64_tr_b16 v[136:137], v252 offset:8192
    v_mfma_f32_16x16x32_bf16 v[28:31], v[140:143], v[188:191], v[28:31]
    ds_read_b64_tr_b16 v[138:139], v252 offset:9216
    v_mfma_f32_16x16x32_bf16 v[32:35], v[140:143], v[192:195], v[32:35]
    ds_read_b128 v[164:167], v236 offset:16384
    v_mfma_f32_16x16x32_bf16 v[84:87], v[144:147], v[180:183], v[84:87]
    ds_read_b128 v[168:171], v236 offset:18432
    v_mfma_f32_16x16x32_bf16 v[88:91], v[144:147], v[184:187], v[88:91]
    v_dot2c_f32_bf16 v217, s54, v144
    v_dot2c_f32_bf16 v217, s54, v145
    v_dot2c_f32_bf16 v217, s54, v146
    v_dot2c_f32_bf16 v217, s54, v147
    ds_read_b128 v[172:175], v236 offset:20480
    v_mfma_f32_16x16x32_bf16 v[92:95], v[144:147], v[188:191], v[92:95]
    ds_read_b128 v[176:179], v236 offset:22528
    v_mfma_f32_16x16x32_bf16 v[96:99], v[144:147], v[192:195], v[96:99]
    ds_read_b64_tr_b16 v[140:141], v253 offset:0
    v_mfma_f32_16x16x32_bf16 v[36:39], v[148:151], v[180:183], v[36:39]
    ds_read_b64_tr_b16 v[142:143], v253 offset:1024
    v_mfma_f32_16x16x32_bf16 v[40:43], v[148:151], v[184:187], v[40:43]
    v_dot2c_f32_bf16 v214, s54, v148
    v_dot2c_f32_bf16 v214, s54, v149
    v_dot2c_f32_bf16 v214, s54, v150
    v_dot2c_f32_bf16 v214, s54, v151
    ds_read_b64_tr_b16 v[144:145], v253 offset:8192
    v_mfma_f32_16x16x32_bf16 v[44:47], v[148:151], v[188:191], v[44:47]
    ds_read_b64_tr_b16 v[146:147], v253 offset:9216
    v_mfma_f32_16x16x32_bf16 v[48:51], v[148:151], v[192:195], v[48:51]
    ds_read_b64_tr_b16 v[148:149], v254 offset:0
    v_mfma_f32_16x16x32_bf16 v[100:103], v[152:155], v[180:183], v[100:103]
    ds_read_b64_tr_b16 v[150:151], v254 offset:1024
    v_mfma_f32_16x16x32_bf16 v[104:107], v[152:155], v[184:187], v[104:107]
    v_dot2c_f32_bf16 v218, s54, v152
    v_dot2c_f32_bf16 v218, s54, v153
    v_dot2c_f32_bf16 v218, s54, v154
    v_dot2c_f32_bf16 v218, s54, v155
    v_mfma_f32_16x16x32_bf16 v[108:111], v[152:155], v[188:191], v[108:111]
    v_mfma_f32_16x16x32_bf16 v[112:115], v[152:155], v[192:195], v[112:115]
    ds_read_b64_tr_b16 v[152:153], v254 offset:8192
    v_mfma_f32_16x16x32_bf16 v[52:55], v[156:159], v[180:183], v[52:55]
    ds_read_b64_tr_b16 v[154:155], v254 offset:9216
    v_mfma_f32_16x16x32_bf16 v[56:59], v[156:159], v[184:187], v[56:59]
    v_dot2c_f32_bf16 v215, s54, v156
    v_dot2c_f32_bf16 v215, s54, v157
    v_dot2c_f32_bf16 v215, s54, v158
    v_dot2c_f32_bf16 v215, s54, v159
    v_mfma_f32_16x16x32_bf16 v[60:63], v[156:159], v[188:191], v[60:63]
    v_mfma_f32_16x16x32_bf16 v[64:67], v[156:159], v[192:195], v[64:67]
    ds_read_b64_tr_b16 v[156:157], v255 offset:0
    v_mfma_f32_16x16x32_bf16 v[116:119], v[160:163], v[180:183], v[116:119]
    ds_read_b64_tr_b16 v[158:159], v255 offset:1024
    v_mfma_f32_16x16x32_bf16 v[120:123], v[160:163], v[184:187], v[120:123]
    v_dot2c_f32_bf16 v219, s54, v160
    v_dot2c_f32_bf16 v219, s54, v161
    v_dot2c_f32_bf16 v219, s54, v162
    v_dot2c_f32_bf16 v219, s54, v163
    v_mfma_f32_16x16x32_bf16 v[124:127], v[160:163], v[188:191], v[124:127]
    v_mfma_f32_16x16x32_bf16 v[128:131], v[160:163], v[192:195], v[128:131]
    ds_read_b64_tr_b16 v[160:161], v255 offset:8192
    s_waitcnt lgkmcnt(11)
    v_mfma_f32_16x16x32_bf16 v[4:7], v[132:135], v[164:167], v[4:7]
    ds_read_b64_tr_b16 v[162:163], v255 offset:9216
    v_mfma_f32_16x16x32_bf16 v[8:11], v[132:135], v[168:171], v[8:11]
    v_mfma_f32_16x16x32_bf16 v[12:15], v[132:135], v[172:175], v[12:15]
    v_mfma_f32_16x16x32_bf16 v[16:19], v[132:135], v[176:179], v[16:19]
    v_permlane32_swap_b32 v212, v214
    v_mfma_f32_16x16x32_bf16 v[68:71], v[136:139], v[164:167], v[68:71]
    v_permlane32_swap_b32 v213, v215
    v_mfma_f32_16x16x32_bf16 v[72:75], v[136:139], v[168:171], v[72:75]
    v_add_f32 v212, v212, v214
    v_mfma_f32_16x16x32_bf16 v[76:79], v[136:139], v[172:175], v[76:79]
    v_add_f32 v213, v213, v215
    v_mfma_f32_16x16x32_bf16 v[80:83], v[136:139], v[176:179], v[80:83]
    v_permlane32_swap_b32 v216, v218
    s_waitcnt lgkmcnt(0)
    s_barrier
    ds_read_b64_tr_b16 v[132:133], v252 offset:32768
    v_mfma_f32_16x16x32_bf16 v[20:23], v[140:143], v[164:167], v[20:23]
    v_permlane32_swap_b32 v217, v219
    ds_read_b64_tr_b16 v[134:135], v252 offset:33792
    v_mfma_f32_16x16x32_bf16 v[24:27], v[140:143], v[168:171], v[24:27]
    v_add_f32 v216, v216, v218
    ds_read_b64_tr_b16 v[136:137], v252 offset:40960
    v_mfma_f32_16x16x32_bf16 v[28:31], v[140:143], v[172:175], v[28:31]
    v_add_f32 v217, v217, v219
    ds_read_b64_tr_b16 v[138:139], v252 offset:41984
    v_mfma_f32_16x16x32_bf16 v[32:35], v[140:143], v[176:179], v[32:35]
    v_permlane16_swap_b32 v212, v213
    ds_read_b128 v[180:183], v237 offset:16384
    v_mfma_f32_16x16x32_bf16 v[84:87], v[144:147], v[164:167], v[84:87]
    v_permlane16_swap_b32 v216, v217
    ds_read_b128 v[184:187], v237 offset:18432
    v_mfma_f32_16x16x32_bf16 v[88:91], v[144:147], v[168:171], v[88:91]
    v_add_f32 v242, v212, v213
    ds_read_b128 v[188:191], v237 offset:20480
    v_mfma_f32_16x16x32_bf16 v[92:95], v[144:147], v[172:175], v[92:95]
    v_add_f32 v243, v216, v217
    ds_read_b128 v[192:195], v237 offset:22528
    v_mfma_f32_16x16x32_bf16 v[96:99], v[144:147], v[176:179], v[96:99]
    ds_read_b64_tr_b16 v[140:141], v253 offset:32768
    v_mfma_f32_16x16x32_bf16 v[36:39], v[148:151], v[164:167], v[36:39]
    ds_read_b64_tr_b16 v[142:143], v253 offset:33792
    v_mfma_f32_16x16x32_bf16 v[40:43], v[148:151], v[168:171], v[40:43]
    ds_read_b64_tr_b16 v[144:145], v253 offset:40960
    v_mfma_f32_16x16x32_bf16 v[44:47], v[148:151], v[172:175], v[44:47]
    ds_read_b64_tr_b16 v[146:147], v253 offset:41984
    v_mfma_f32_16x16x32_bf16 v[48:51], v[148:151], v[176:179], v[48:51]
    ds_read_b64_tr_b16 v[148:149], v254 offset:32768
    v_mfma_f32_16x16x32_bf16 v[100:103], v[152:155], v[164:167], v[100:103]
    ds_read_b64_tr_b16 v[150:151], v254 offset:33792
    v_mfma_f32_16x16x32_bf16 v[104:107], v[152:155], v[168:171], v[104:107]
    v_mfma_f32_16x16x32_bf16 v[108:111], v[152:155], v[172:175], v[108:111]
    v_mfma_f32_16x16x32_bf16 v[112:115], v[152:155], v[176:179], v[112:115]
    ds_read_b64_tr_b16 v[152:153], v254 offset:40960
    v_mfma_f32_16x16x32_bf16 v[52:55], v[156:159], v[164:167], v[52:55]
    ds_read_b64_tr_b16 v[154:155], v254 offset:41984
    v_mfma_f32_16x16x32_bf16 v[56:59], v[156:159], v[168:171], v[56:59]
    v_mfma_f32_16x16x32_bf16 v[60:63], v[156:159], v[172:175], v[60:63]
    v_mfma_f32_16x16x32_bf16 v[64:67], v[156:159], v[176:179], v[64:67]
    ds_read_b64_tr_b16 v[156:157], v255 offset:32768
    v_mfma_f32_16x16x32_bf16 v[116:119], v[160:163], v[164:167], v[116:119]
    ds_read_b64_tr_b16 v[158:159], v255 offset:33792
    v_mfma_f32_16x16x32_bf16 v[120:123], v[160:163], v[168:171], v[120:123]
    v_mfma_f32_16x16x32_bf16 v[124:127], v[160:163], v[172:175], v[124:127]
    v_mfma_f32_16x16x32_bf16 v[128:131], v[160:163], v[176:179], v[128:131]
    ds_read_b64_tr_b16 v[160:161], v255 offset:40960
    s_waitcnt lgkmcnt(11)
    v_mfma_f32_16x16x32_bf16 v[4:7], v[132:135], v[180:183], v[4:7]
    ds_read_b64_tr_b16 v[162:163], v255 offset:41984
    v_mfma_f32_16x16x32_bf16 v[8:11], v[132:135], v[184:187], v[8:11]
    v_mfma_f32_16x16x32_bf16 v[12:15], v[132:135], v[188:191], v[12:15]
    v_mfma_f32_16x16x32_bf16 v[16:19], v[132:135], v[192:195], v[16:19]
    v_mfma_f32_16x16x32_bf16 v[68:71], v[136:139], v[180:183], v[68:71]
    v_mfma_f32_16x16x32_bf16 v[72:75], v[136:139], v[184:187], v[72:75]
    v_mfma_f32_16x16x32_bf16 v[76:79], v[136:139], v[188:191], v[76:79]
    v_mfma_f32_16x16x32_bf16 v[80:83], v[136:139], v[192:195], v[80:83]
    s_waitcnt lgkmcnt(0)
    s_barrier
    ds_read_b64_tr_b16 v[132:133], v252 offset:49152
    v_mfma_f32_16x16x32_bf16 v[20:23], v[140:143], v[180:183], v[20:23]
    ds_read_b64_tr_b16 v[134:135], v252 offset:50176
    v_mfma_f32_16x16x32_bf16 v[24:27], v[140:143], v[184:187], v[24:27]
    ds_read_b64_tr_b16 v[136:137], v252 offset:57344
    v_mfma_f32_16x16x32_bf16 v[28:31], v[140:143], v[188:191], v[28:31]
    ds_read_b64_tr_b16 v[138:139], v252 offset:58368
    v_mfma_f32_16x16x32_bf16 v[32:35], v[140:143], v[192:195], v[32:35]
    ds_read_b128 v[164:167], v234 offset:0
    v_mfma_f32_16x16x32_bf16 v[84:87], v[144:147], v[180:183], v[84:87]
    ds_read_b128 v[168:171], v234 offset:2048
    v_mfma_f32_16x16x32_bf16 v[88:91], v[144:147], v[184:187], v[88:91]
    ds_read_b128 v[172:175], v234 offset:4096
    v_mfma_f32_16x16x32_bf16 v[92:95], v[144:147], v[188:191], v[92:95]
    ds_read_b128 v[176:179], v234 offset:6144
    v_mfma_f32_16x16x32_bf16 v[96:99], v[144:147], v[192:195], v[96:99]
    ds_read_b64_tr_b16 v[140:141], v253 offset:49152
    v_mfma_f32_16x16x32_bf16 v[36:39], v[148:151], v[180:183], v[36:39]
    ds_read_b64_tr_b16 v[142:143], v253 offset:50176
    v_mfma_f32_16x16x32_bf16 v[40:43], v[148:151], v[184:187], v[40:43]
    ds_read_b64_tr_b16 v[144:145], v253 offset:57344
    v_mfma_f32_16x16x32_bf16 v[44:47], v[148:151], v[188:191], v[44:47]
    ds_read_b64_tr_b16 v[146:147], v253 offset:58368
    v_mfma_f32_16x16x32_bf16 v[48:51], v[148:151], v[192:195], v[48:51]
    ds_read_b64_tr_b16 v[148:149], v254 offset:49152
    v_mfma_f32_16x16x32_bf16 v[100:103], v[152:155], v[180:183], v[100:103]
    ds_read_b64_tr_b16 v[150:151], v254 offset:50176
    v_mfma_f32_16x16x32_bf16 v[104:107], v[152:155], v[184:187], v[104:107]
    v_mfma_f32_16x16x32_bf16 v[108:111], v[152:155], v[188:191], v[108:111]
    v_mfma_f32_16x16x32_bf16 v[112:115], v[152:155], v[192:195], v[112:115]
    ds_read_b64_tr_b16 v[152:153], v254 offset:57344
    v_mfma_f32_16x16x32_bf16 v[52:55], v[156:159], v[180:183], v[52:55]
    ds_read_b64_tr_b16 v[154:155], v254 offset:58368
    v_mfma_f32_16x16x32_bf16 v[56:59], v[156:159], v[184:187], v[56:59]
    v_mfma_f32_16x16x32_bf16 v[60:63], v[156:159], v[188:191], v[60:63]
    v_mfma_f32_16x16x32_bf16 v[64:67], v[156:159], v[192:195], v[64:67]
    ds_read_b64_tr_b16 v[156:157], v255 offset:49152
    v_mfma_f32_16x16x32_bf16 v[116:119], v[160:163], v[180:183], v[116:119]
    ds_read_b64_tr_b16 v[158:159], v255 offset:50176
    v_mfma_f32_16x16x32_bf16 v[120:123], v[160:163], v[184:187], v[120:123]
    v_mfma_f32_16x16x32_bf16 v[124:127], v[160:163], v[188:191], v[124:127]
    v_mfma_f32_16x16x32_bf16 v[128:131], v[160:163], v[192:195], v[128:131]
    ds_read_b64_tr_b16 v[160:161], v255 offset:57344
    s_movk_i32 s77, 600
    s_waitcnt vmcnt(0)
    v_readfirstlane_b32 s67, v238
    s_nop 0
    s_sub_u32 s76, s44, s67
    s_cmp_lt_i32 s76, s77
    s_cselect_b32 s76, s67, 0
    s_cmp_lg_u32 s76, 0
    s_cbranch_scc1 Lnok_33
    s_mov_b32 s68, 200000
Lnon_32:
    buffer_load_dword v238, off, s[28:31], 0 sc1
    s_waitcnt vmcnt(0)
    v_readfirstlane_b32 s67, v238
    s_nop 0
    s_sub_u32 s76, s44, s67
    s_cmp_lt_i32 s76, s77
    s_cselect_b32 s76, s67, 0
    s_cmp_lg_u32 s76, 0
    s_cbranch_scc1 Lnok_33
    s_sub_u32 s68, s68, 1
    s_cmp_lt_u32 s68, 199900
    s_cselect_b32 s77, 0x7fffffff, s77
    s_cmp_lg_u32 s68, 0
    s_cbranch_scc1 Lnon_32
Lnok_33:
    s_waitcnt lgkmcnt(11)
    v_mfma_f32_16x16x32_bf16 v[4:7], v[132:135], v[164:167], v[4:7]
    ds_read_b64_tr_b16 v[162:163], v255 offset:58368
    v_mfma_f32_16x16x32_bf16 v[8:11], v[132:135], v[168:171], v[8:11]
    v_mfma_f32_16x16x32_bf16 v[12:15], v[132:135], v[172:175], v[12:15]
    v_mfma_f32_16x16x32_bf16 v[16:19], v[132:135], v[176:179], v[16:19]
    v_mfma_f32_16x16x32_bf16 v[68:71], v[136:139], v[164:167], v[68:71]
    v_mfma_f32_16x16x32_bf16 v[72:75], v[136:139], v[168:171], v[72:75]
    v_mfma_f32_16x16x32_bf16 v[76:79], v[136:139], v[172:175], v[76:79]
    v_mfma_f32_16x16x32_bf16 v[80:83], v[136:139], v[176:179], v[80:83]
    s_waitcnt lgkmcnt(0)
    s_barrier
    ds_read_b64_tr_b16 v[132:133], v248 offset:16384
    v_mfma_f32_16x16x32_bf16 v[20:23], v[140:143], v[164:167], v[20:23]
    ds_read_b64_tr_b16 v[134:135], v248 offset:17408
    v_mfma_f32_16x16x32_bf16 v[24:27], v[140:143], v[168:171], v[24:27]
    ds_read_b64_tr_b16 v[136:137], v248 offset:24576
    v_mfma_f32_16x16x32_bf16 v[28:31], v[140:143], v[172:175], v[28:31]
    ds_read_b64_tr_b16 v[138:139], v248 offset:25600
    v_mfma_f32_16x16x32_bf16 v[32:35], v[140:143], v[176:179], v[32:35]
    ds_read_b128 v[180:183], v235 offset:0
    v_mfma_f32_16x16x32_bf16 v[84:87], v[144:147], v[164:167], v[84:87]
    ds_read_b128 v[184:187], v235 offset:2048
    v_mfma_f32_16x16x32_bf16 v[88:91], v[144:147], v[168:171], v[88:91]
    ds_read_b128 v[188:191], v235 offset:4096
    v_mfma_f32_16x16x32_bf16 v[92:95], v[144:147], v[172:175], v[92:95]
    ds_read_b128 v[192:195], v235 offset:6144
    v_mfma_f32_16x16x32_bf16 v[96:99], v[144:147], v[176:179], v[96:99]
    ds_read_b64_tr_b16 v[140:141], v249 offset:16384
    v_mfma_f32_16x16x32_bf16 v[36:39], v[148:151], v[164:167], v[36:39]
    ds_read_b64_tr_b16 v[142:143], v249 offset:17408
    v_mfma_f32_16x16x32_bf16 v[40:43], v[148:151], v[168:171], v[40:43]
    ds_read_b64_tr_b16 v[144:145], v249 offset:24576
    v_mfma_f32_16x16x32_bf16 v[44:47], v[148:151], v[172:175], v[44:47]
    ds_read_b64_tr_b16 v[146:147], v249 offset:25600
    v_mfma_f32_16x16x32_bf16 v[48:51], v[148:151], v[176:179], v[48:51]
    ds_read_b64_tr_b16 v[148:149], v250 offset:16384
    v_mfma_f32_16x16x32_bf16 v[100:103], v[152:155], v[164:167], v[100:103]
    ds_read_b64_tr_b16 v[150:151], v250 offset:17408
    v_mfma_f32_16x16x32_bf16 v[104:107], v[152:155], v[168:171], v[104:107]
    ds_read_b64_tr_b16 v[196:197], v244 offset:0
    v_mfma_f32_16x16x32_bf16 v[108:111], v[152:155], v[172:175], v[108:111]
    ds_read_b64_tr_b16 v[198:199], v244 offset:2048
    v_mfma_f32_16x16x32_bf16 v[112:115], v[152:155], v[176:179], v[112:115]
    ds_read_b64_tr_b16 v[152:153], v250 offset:24576
    v_mfma_f32_16x16x32_bf16 v[52:55], v[156:159], v[164:167], v[52:55]
    ds_read_b64_tr_b16 v[154:155], v250 offset:25600
    v_mfma_f32_16x16x32_bf16 v[56:59], v[156:159], v[168:171], v[56:59]
    ds_read_b64_tr_b16 v[200:201], v245 offset:0
    v_mfma_f32_16x16x32_bf16 v[60:63], v[156:159], v[172:175], v[60:63]
    ds_read_b64_tr_b16 v[202:203], v245 offset:2048
    v_mfma_f32_16x16x32_bf16 v[64:67], v[156:159], v[176:179], v[64:67]
    ds_read_b64_tr_b16 v[156:157], v251 offset:16384
    v_mfma_f32_16x16x32_bf16 v[116:119], v[160:163], v[164:167], v[116:119]
    ds_read_b64_tr_b16 v[158:159], v251 offset:17408
    v_mfma_f32_16x16x32_bf16 v[120:123], v[160:163], v[168:171], v[120:123]
    ds_read_b64_tr_b16 v[204:205], v246 offset:0
    v_mfma_f32_16x16x32_bf16 v[124:127], v[160:163], v[172:175], v[124:127]
    ds_read_b64_tr_b16 v[206:207], v246 offset:2048
    v_mfma_f32_16x16x32_bf16 v[128:131], v[160:163], v[176:179], v[128:131]
    ds_read_b64_tr_b16 v[160:161], v251 offset:24576
    s_waitcnt lgkmcnt(15)
    v_mfma_f32_16x16x32_bf16 v[4:7], v[132:135], v[180:183], v[4:7]
    ds_read_b64_tr_b16 v[162:163], v251 offset:25600
    v_mfma_f32_16x16x32_bf16 v[8:11], v[132:135], v[184:187], v[8:11]
    ds_read_b64_tr_b16 v[208:209], v247 offset:0
    v_mfma_f32_16x16x32_bf16 v[12:15], v[132:135], v[188:191], v[12:15]
    ds_read_b64_tr_b16 v[210:211], v247 offset:2048
    v_mfma_f32_16x16x32_bf16 v[16:19], v[132:135], v[192:195], v[16:19]
    v_mfma_f32_16x16x32_bf16 v[68:71], v[136:139], v[180:183], v[68:71]
    v_mfma_f32_16x16x32_bf16 v[72:75], v[136:139], v[184:187], v[72:75]
    v_mfma_f32_16x16x32_bf16 v[76:79], v[136:139], v[188:191], v[76:79]
    v_mfma_f32_16x16x32_bf16 v[80:83], v[136:139], v[192:195], v[80:83]
    s_waitcnt lgkmcnt(0)
    s_barrier
    ds_read_b64_tr_b16 v[132:133], v248 offset:32768
    v_mfma_f32_16x16x32_bf16 v[20:23], v[140:143], v[180:183], v[20:23]
    ds_read_b64_tr_b16 v[134:135], v248 offset:33792
    v_mfma_f32_16x16x32_bf16 v[24:27], v[140:143], v[184:187], v[24:27]
    ds_read_b64_tr_b16 v[136:137], v248 offset:40960
    v_mfma_f32_16x16x32_bf16 v[28:31], v[140:143], v[188:191], v[28:31]
    ds_read_b64_tr_b16 v[138:139], v248 offset:41984
    v_mfma_f32_16x16x32_bf16 v[32:35], v[140:143], v[192:195], v[32:35]
    ds_read_b128 v[164:167], v234 offset:49152
    v_mfma_f32_16x16x32_bf16 v[84:87], v[144:147], v[180:183], v[84:87]
    ds_read_b128 v[168:171], v234 offset:51200
    v_mfma_f32_16x16x32_bf16 v[88:91], v[144:147], v[184:187], v[88:91]
    ds_read_b128 v[172:175], v234 offset:53248
    v_mfma_f32_16x16x32_bf16 v[92:95], v[144:147], v[188:191], v[92:95]
    ds_read_b128 v[176:179], v234 offset:55296
    v_mfma_f32_16x16x32_bf16 v[96:99], v[144:147], v[192:195], v[96:99]
    ds_read_b64_tr_b16 v[140:141], v249 offset:32768
    v_mfma_f32_16x16x32_bf16 v[36:39], v[148:151], v[180:183], v[36:39]
    ds_read_b64_tr_b16 v[142:143], v249 offset:33792
    v_mfma_f32_16x16x32_bf16 v[40:43], v[148:151], v[184:187], v[40:43]
    ds_read_b64_tr_b16 v[144:145], v249 offset:40960
    v_mfma_f32_16x16x32_bf16 v[44:47], v[148:151], v[188:191], v[44:47]
    ds_read_b64_tr_b16 v[146:147], v249 offset:41984
    v_mfma_f32_16x16x32_bf16 v[48:51], v[148:151], v[192:195], v[48:51]
    ds_read_b64_tr_b16 v[148:149], v250 offset:32768
    v_mfma_f32_16x16x32_bf16 v[100:103], v[152:155], v[180:183], v[100:103]
    ds_read_b64_tr_b16 v[150:151], v250 offset:33792
    v_mfma_f32_16x16x32_bf16 v[104:107], v[152:155], v[184:187], v[104:107]
    ds_read_b64_tr_b16 v[212:213], v244 offset:16384
    v_mfma_f32_16x16x32_bf16 v[108:111], v[152:155], v[188:191], v[108:111]
    ds_read_b64_tr_b16 v[214:215], v244 offset:18432
    v_mfma_f32_16x16x32_bf16 v[112:115], v[152:155], v[192:195], v[112:115]
    ds_read_b64_tr_b16 v[152:153], v250 offset:40960
    v_mfma_f32_16x16x32_bf16 v[52:55], v[156:159], v[180:183], v[52:55]
    ds_read_b64_tr_b16 v[154:155], v250 offset:41984
    v_mfma_f32_16x16x32_bf16 v[56:59], v[156:159], v[184:187], v[56:59]
    ds_read_b64_tr_b16 v[216:217], v245 offset:16384
    v_mfma_f32_16x16x32_bf16 v[60:63], v[156:159], v[188:191], v[60:63]
    ds_read_b64_tr_b16 v[218:219], v245 offset:18432
    v_mfma_f32_16x16x32_bf16 v[64:67], v[156:159], v[192:195], v[64:67]
    ds_read_b64_tr_b16 v[156:157], v251 offset:32768
    v_mfma_f32_16x16x32_bf16 v[116:119], v[160:163], v[180:183], v[116:119]
    ds_read_b64_tr_b16 v[158:159], v251 offset:33792
    v_mfma_f32_16x16x32_bf16 v[120:123], v[160:163], v[184:187], v[120:123]
    ds_read_b64_tr_b16 v[220:221], v246 offset:16384
    v_mfma_f32_16x16x32_bf16 v[124:127], v[160:163], v[188:191], v[124:127]
    ds_read_b64_tr_b16 v[222:223], v246 offset:18432
    v_mfma_f32_16x16x32_bf16 v[128:131], v[160:163], v[192:195], v[128:131]
    ds_read_b64_tr_b16 v[160:161], v251 offset:40960
    s_waitcnt lgkmcnt(15)
    v_mfma_f32_16x16x32_bf16 v[4:7], v[132:135], v[164:167], v[4:7]
    ds_read_b64_tr_b16 v[162:163], v251 offset:41984
    v_mfma_f32_16x16x32_bf16 v[8:11], v[132:135], v[168:171], v[8:11]
    ds_read_b64_tr_b16 v[224:225], v247 offset:16384
    v_mfma_f32_16x16x32_bf16 v[12:15], v[132:135], v[172:175], v[12:15]
    ds_read_b64_tr_b16 v[226:227], v247 offset:18432
    v_mfma_f32_16x16x32_bf16 v[16:19], v[132:135], v[176:179], v[16:19]
    v_mfma_f32_16x16x32_bf16 v[68:71], v[136:139], v[164:167], v[68:71]
    v_mfma_f32_16x16x32_bf16 v[72:75], v[136:139], v[168:171], v[72:75]
    v_mfma_f32_16x16x32_bf16 v[76:79], v[136:139], v[172:175], v[76:79]
    v_mfma_f32_16x16x32_bf16 v[80:83], v[136:139], v[176:179], v[80:83]
    s_waitcnt lgkmcnt(0)
    s_barrier
    ds_read_b64_tr_b16 v[132:133], v252 offset:0
    v_mfma_f32_16x16x32_bf16 v[20:23], v[140:143], v[164:167], v[20:23]
    ds_read_b64_tr_b16 v[134:135], v252 offset:1024
    v_mfma_f32_16x16x32_bf16 v[24:27], v[140:143], v[168:171], v[24:27]
    ds_read_b64_tr_b16 v[136:137], v252 offset:8192
    v_mfma_f32_16x16x32_bf16 v[28:31], v[140:143], v[172:175], v[28:31]
    ds_read_b64_tr_b16 v[138:139], v252 offset:9216
    v_mfma_f32_16x16x32_bf16 v[32:35], v[140:143], v[176:179], v[32:35]
    ds_read_b128 v[180:183], v235 offset:49152
    v_mfma_f32_16x16x32_bf16 v[84:87], v[144:147], v[164:167], v[84:87]
    ds_read_b128 v[184:187], v235 offset:51200
    v_mfma_f32_16x16x32_bf16 v[88:91], v[144:147], v[168:171], v[88:91]
    ds_read_b128 v[188:191], v235 offset:53248
    v_mfma_f32_16x16x32_bf16 v[92:95], v[144:147], v[172:175], v[92:95]
    ds_read_b128 v[192:195], v235 offset:55296
    v_mfma_f32_16x16x32_bf16 v[96:99], v[144:147], v[176:179], v[96:99]
    ds_read_b64_tr_b16 v[140:141], v253 offset:0
    v_mfma_f32_16x16x32_bf16 v[36:39], v[148:151], v[164:167], v[36:39]
    ds_read_b64_tr_b16 v[142:143], v253 offset:1024
    v_mfma_f32_16x16x32_bf16 v[40:43], v[148:151], v[168:171], v[40:43]
    ds_read_b64_tr_b16 v[144:145], v253 offset:8192
    v_mfma_f32_16x16x32_bf16 v[44:47], v[148:151], v[172:175], v[44:47]
    ds_read_b64_tr_b16 v[146:147], v253 offset:9216
    v_mfma_f32_16x16x32_bf16 v[48:51], v[148:151], v[176:179], v[48:51]
    ds_read_b64_tr_b16 v[148:149], v254 offset:0
    v_mfma_f32_16x16x32_bf16 v[100:103], v[152:155], v[164:167], v[100:103]
    ds_read_b64_tr_b16 v[150:151], v254 offset:1024
    v_mfma_f32_16x16x32_bf16 v[104:107], v[152:155], v[168:171], v[104:107]
    v_mfma_f32_16x16x32_bf16 v[108:111], v[152:155], v[172:175], v[108:111]
    v_mfma_f32_16x16x32_bf16 v[112:115], v[152:155], v[176:179], v[112:115]
    ds_read_b64_tr_b16 v[152:153], v254 offset:8192
    v_mfma_f32_16x16x32_bf16 v[52:55], v[156:159], v[164:167], v[52:55]
    ds_read_b64_tr_b16 v[154:155], v254 offset:9216
    v_mfma_f32_16x16x32_bf16 v[56:59], v[156:159], v[168:171], v[56:59]
    v_mfma_f32_16x16x32_bf16 v[60:63], v[156:159], v[172:175], v[60:63]
    v_mfma_f32_16x16x32_bf16 v[64:67], v[156:159], v[176:179], v[64:67]
    ds_read_b64_tr_b16 v[156:157], v255 offset:0
    v_mfma_f32_16x16x32_bf16 v[116:119], v[160:163], v[164:167], v[116:119]
    ds_read_b64_tr_b16 v[158:159], v255 offset:1024
    v_mfma_f32_16x16x32_bf16 v[120:123], v[160:163], v[168:171], v[120:123]
    v_mfma_f32_16x16x32_bf16 v[124:127], v[160:163], v[172:175], v[124:127]
    v_mfma_f32_16x16x32_bf16 v[128:131], v[160:163], v[176:179], v[128:131]
    ds_read_b64_tr_b16 v[160:161], v255 offset:8192
    s_waitcnt lgkmcnt(11)
    v_mfma_f32_16x16x32_bf16 v[4:7], v[132:135], v[180:183], v[4:7]
    ds_read_b64_tr_b16 v[162:163], v255 offset:9216
    v_mfma_f32_16x16x32_bf16 v[8:11], v[132:135], v[184:187], v[8:11]
    ds_read_b128 v[164:167], v236 offset:32768
    buffer_load_dwordx4 v[228:231], v2, s[20:23], s71 offen sc1
    v_mfma_f32_16x16x32_bf16 v[12:15], v[132:135], v[188:191], v[12:15]
    ds_read_b128 v[168:171], v236 offset:34816
    v_mfma_f32_16x16x32_bf16 v[16:19], v[132:135], v[192:195], v[16:19]
    ds_read_b128 v[172:175], v236 offset:36864
    v_mfma_f32_16x16x32_bf16 v[68:71], v[136:139], v[180:183], v[68:71]
    ds_read_b128 v[176:179], v236 offset:38912
    v_mfma_f32_16x16x32_bf16 v[72:75], v[136:139], v[184:187], v[72:75]
    ds_read_b64_tr_b16 v[132:133], v252 offset:16384
    buffer_load_dwordx2 v[232:233], v3, s[20:23], s73 offen sc1
    v_mfma_f32_16x16x32_bf16 v[76:79], v[136:139], v[188:191], v[76:79]
    ds_read_b64_tr_b16 v[134:135], v252 offset:17408
    v_mfma_f32_16x16x32_bf16 v[80:83], v[136:139], v[192:195], v[80:83]
    ds_read_b64_tr_b16 v[136:137], v252 offset:24576
    s_waitcnt lgkmcnt(15)
    v_mfma_f32_16x16x32_bf16 v[20:23], v[140:143], v[180:183], v[20:23]
    ds_read_b64_tr_b16 v[138:139], v252 offset:25600
    v_mfma_f32_16x16x32_bf16 v[24:27], v[140:143], v[184:187], v[24:27]
    v_mfma_f32_16x16x32_bf16 v[28:31], v[140:143], v[188:191], v[28:31]
    v_mfma_f32_16x16x32_bf16 v[32:35], v[140:143], v[192:195], v[32:35]
    ds_read_b64_tr_b16 v[140:141], v253 offset:16384
    v_mfma_f32_16x16x32_bf16 v[84:87], v[144:147], v[180:183], v[84:87]
    ds_read_b64_tr_b16 v[142:143], v253 offset:17408
    v_mfma_f32_16x16x32_bf16 v[88:91], v[144:147], v[184:187], v[88:91]
    v_mfma_f32_16x16x32_bf16 v[92:95], v[144:147], v[188:191], v[92:95]
    v_mfma_f32_16x16x32_bf16 v[96:99], v[144:147], v[192:195], v[96:99]
    ds_read_b64_tr_b16 v[144:145], v253 offset:24576
    s_waitcnt lgkmcnt(15)
    v_mfma_f32_16x16x32_bf16 v[36:39], v[148:151], v[180:183], v[36:39]
    ds_read_b64_tr_b16 v[146:147], v253 offset:25600
    v_mfma_f32_16x16x32_bf16 v[40:43], v[148:151], v[184:187], v[40:43]
    v_mfma_f32_16x16x32_bf16 v[44:47], v[148:151], v[188:191], v[44:47]
    v_mfma_f32_16x16x32_bf16 v[48:51], v[148:151], v[192:195], v[48:51]
    ds_read_b64_tr_b16 v[148:149], v254 offset:16384
    v_mfma_f32_16x16x32_bf16 v[100:103], v[152:155], v[180:183], v[100:103]
    ds_read_b64_tr_b16 v[150:151], v254 offset:17408
    v_mfma_f32_16x16x32_bf16 v[104:107], v[152:155], v[184:187], v[104:107]
    v_mfma_f32_16x16x32_bf16 v[108:111], v[152:155], v[188:191], v[108:111]
    v_mfma_f32_16x16x32_bf16 v[112:115], v[152:155], v[192:195], v[112:115]
    ds_read_b64_tr_b16 v[152:153], v254 offset:24576
    s_waitcnt lgkmcnt(15)
    v_mfma_f32_16x16x32_bf16 v[52:55], v[156:159], v[180:183], v[52:55]
    ds_read_b64_tr_b16 v[154:155], v254 offset:25600
    v_mfma_f32_16x16x32_bf16 v[56:59], v[156:159], v[184:187], v[56:59]
    v_mfma_f32_16x16x32_bf16 v[60:63], v[156:159], v[188:191], v[60:63]
    v_mfma_f32_16x16x32_bf16 v[64:67], v[156:159], v[192:195], v[64:67]
    ds_read_b64_tr_b16 v[156:157], v255 offset:16384
    v_mfma_f32_16x16x32_bf16 v[116:119], v[160:163], v[180:183], v[116:119]
    ds_read_b64_tr_b16 v[158:159], v255 offset:17408
    v_mfma_f32_16x16x32_bf16 v[120:123], v[160:163], v[184:187], v[120:123]
    v_mfma_f32_16x16x32_bf16 v[124:127], v[160:163], v[188:191], v[124:127]
    v_mfma_f32_16x16x32_bf16 v[128:131], v[160:163], v[192:195], v[128:131]
    ds_read_b64_tr_b16 v[160:161], v255 offset:24576
    s_waitcnt lgkmcnt(11)
    v_mfma_f32_16x16x32_bf16 v[4:7], v[132:135], v[164:167], v[4:7]
    ds_read_b64_tr_b16 v[162:163], v255 offset:25600
    v_mfma_f32_16x16x32_bf16 v[8:11], v[132:135], v[168:171], v[8:11]
    ds_read_b128 v[180:183], v237 offset:32768
    v_mfma_f32_16x16x32_bf16 v[12:15], v[132:135], v[172:175], v[12:15]
    ds_read_b128 v[184:187], v237 offset:34816
    v_mfma_f32_16x16x32_bf16 v[16:19], v[132:135], v[176:179], v[16:19]
    ds_read_b128 v[188:191], v237 offset:36864
    v_mfma_f32_16x16x32_bf16 v[68:71], v[136:139], v[164:167], v[68:71]
    ds_read_b128 v[192:195], v237 offset:38912
    v_mfma_f32_16x16x32_bf16 v[72:75], v[136:139], v[168:171], v[72:75]
    ds_read_b64_tr_b16 v[132:133], v252 offset:49152
    v_mfma_f32_16x16x32_bf16 v[76:79], v[136:139], v[172:175], v[76:79]
    ds_read_b64_tr_b16 v[134:135], v252 offset:50176
    v_mfma_f32_16x16x32_bf16 v[80:83], v[136:139], v[176:179], v[80:83]
    ds_read_b64_tr_b16 v[136:137], v252 offset:57344
    s_waitcnt lgkmcnt(15)
    v_mfma_f32_16x16x32_bf16 v[20:23], v[140:143], v[164:167], v[20:23]
    ds_read_b64_tr_b16 v[138:139], v252 offset:58368
    v_mfma_f32_16x16x32_bf16 v[24:27], v[140:143], v[168:171], v[24:27]
    v_mfma_f32_16x16x32_bf16 v[28:31], v[140:143], v[172:175], v[28:31]
    v_mfma_f32_16x16x32_bf16 v[32:35], v[140:143], v[176:179], v[32:35]
    ds_read_b64_tr_b16 v[140:141], v253 offset:49152
    v_mfma_f32_16x16x32_bf16 v[84:87], v[144:147], v[164:167], v[84:87]
    ds_read_b64_tr_b16 v[142:143], v253 offset:50176
    v_mfma_f32_16x16x32_bf16 v[88:91], v[144:147], v[168:171], v[88:91]
    v_mfma_f32_16x16x32_bf16 v[92:95], v[144:147], v[172:175], v[92:95]
    v_mfma_f32_16x16x32_bf16 v[96:99], v[144:147], v[176:179], v[96:99]
    ds_read_b64_tr_b16 v[144:145], v253 offset:57344
    s_waitcnt lgkmcnt(15)
    v_mfma_f32_16x16x32_bf16 v[36:39], v[148:151], v[164:167], v[36:39]
    ds_read_b64_tr_b16 v[146:147], v253 offset:58368
    v_mfma_f32_16x16x32_bf16 v[40:43], v[148:151], v[168:171], v[40:43]
    v_mfma_f32_16x16x32_bf16 v[44:47], v[148:151], v[172:175], v[44:47]
    v_mfma_f32_16x16x32_bf16 v[48:51], v[148:151], v[176:179], v[48:51]
    ds_read_b64_tr_b16 v[148:149], v254 offset:49152
    v_mfma_f32_16x16x32_bf16 v[100:103], v[152:155], v[164:167], v[100:103]
    ds_read_b64_tr_b16 v[150:151], v254 offset:50176
    v_mfma_f32_16x16x32_bf16 v[104:107], v[152:155], v[168:171], v[104:107]
    v_mfma_f32_16x16x32_bf16 v[108:111], v[152:155], v[172:175], v[108:111]
    v_mfma_f32_16x16x32_bf16 v[112:115], v[152:155], v[176:179], v[112:115]
    ds_read_b64_tr_b16 v[152:153], v254 offset:57344
    s_waitcnt lgkmcnt(15)
    v_mfma_f32_16x16x32_bf16 v[52:55], v[156:159], v[164:167], v[52:55]
    ds_read_b64_tr_b16 v[154:155], v254 offset:58368
    v_mfma_f32_16x16x32_bf16 v[56:59], v[156:159], v[168:171], v[56:59]
    v_mfma_f32_16x16x32_bf16 v[60:63], v[156:159], v[172:175], v[60:63]
    v_mfma_f32_16x16x32_bf16 v[64:67], v[156:159], v[176:179], v[64:67]
    ds_read_b64_tr_b16 v[156:157], v255 offset:49152
    v_mfma_f32_16x16x32_bf16 v[116:119], v[160:163], v[164:167], v[116:119]
    ds_read_b64_tr_b16 v[158:159], v255 offset:50176
    v_mfma_f32_16x16x32_bf16 v[120:123], v[160:163], v[168:171], v[120:123]
    v_mfma_f32_16x16x32_bf16 v[124:127], v[160:163], v[172:175], v[124:127]
    v_mfma_f32_16x16x32_bf16 v[128:131], v[160:163], v[176:179], v[128:131]
    ds_read_b64_tr_b16 v[160:161], v255 offset:57344
    s_waitcnt lgkmcnt(11)
    v_mfma_f32_16x16x32_bf16 v[4:7], v[132:135], v[180:183], v[4:7]
    ds_read_b64_tr_b16 v[162:163], v255 offset:58368
    v_mfma_f32_16x16x32_bf16 v[8:11], v[132:135], v[184:187], v[8:11]
    v_mfma_f32_16x16x32_bf16 v[12:15], v[132:135], v[188:191], v[12:15]
    v_mfma_f32_16x16x32_bf16 v[16:19], v[132:135], v[192:195], v[16:19]
    v_mfma_f32_16x16x32_bf16 v[68:71], v[136:139], v[180:183], v[68:71]
    v_mfma_f32_16x16x32_bf16 v[72:75], v[136:139], v[184:187], v[72:75]
    v_mfma_f32_16x16x32_bf16 v[76:79], v[136:139], v[188:191], v[76:79]
    v_mfma_f32_16x16x32_bf16 v[80:83], v[136:139], v[192:195], v[80:83]
    s_waitcnt lgkmcnt(8)
    v_mfma_f32_16x16x32_bf16 v[20:23], v[140:143], v[180:183], v[20:23]
    v_mfma_f32_16x16x32_bf16 v[24:27], v[140:143], v[184:187], v[24:27]
    v_mfma_f32_16x16x32_bf16 v[28:31], v[140:143], v[188:191], v[28:31]
    v_mfma_f32_16x16x32_bf16 v[32:35], v[140:143], v[192:195], v[32:35]
    v_mfma_f32_16x16x32_bf16 v[84:87], v[144:147], v[180:183], v[84:87]
    v_mfma_f32_16x16x32_bf16 v[88:91], v[144:147], v[184:187], v[88:91]
    v_mfma_f32_16x16x32_bf16 v[92:95], v[144:147], v[188:191], v[92:95]
    v_mfma_f32_16x16x32_bf16 v[96:99], v[144:147], v[192:195], v[96:99]
    s_waitcnt lgkmcnt(4)
    v_mfma_f32_16x16x32_bf16 v[36:39], v[148:151], v[180:183], v[36:39]
    v_mfma_f32_16x16x32_bf16 v[40:43], v[148:151], v[184:187], v[40:43]
    v_mfma_f32_16x16x32_bf16 v[44:47], v[148:151], v[188:191], v[44:47]
    v_mfma_f32_16x16x32_bf16 v[48:51], v[148:151], v[192:195], v[48:51]
    v_mfma_f32_16x16x32_bf16 v[100:103], v[152:155], v[180:183], v[100:103]
    v_mfma_f32_16x16x32_bf16 v[104:107], v[152:155], v[184:187], v[104:107]
    v_mfma_f32_16x16x32_bf16 v[108:111], v[152:155], v[188:191], v[108:111]
    v_mfma_f32_16x16x32_bf16 v[112:115], v[152:155], v[192:195], v[112:115]
    s_waitcnt lgkmcnt(0)
    v_mfma_f32_16x16x32_bf16 v[52:55], v[156:159], v[180:183], v[52:55]
    v_mfma_f32_16x16x32_bf16 v[56:59], v[156:159], v[184:187], v[56:59]
    v_mfma_f32_16x16x32_bf16 v[60:63], v[156:159], v[188:191], v[60:63]
    v_mfma_f32_16x16x32_bf16 v[64:67], v[156:159], v[192:195], v[64:67]
    v_mfma_f32_16x16x32_bf16 v[116:119], v[160:163], v[180:183], v[116:119]
    v_mfma_f32_16x16x32_bf16 v[120:123], v[160:163], v[184:187], v[120:123]
    v_mfma_f32_16x16x32_bf16 v[124:127], v[160:163], v[188:191], v[124:127]
    v_mfma_f32_16x16x32_bf16 v[128:131], v[160:163], v[192:195], v[128:131]
    s_waitcnt vmcnt(0)
    v_cmp_ne_u32 vcc, s67, v229
    v_cmp_ne_u32 s[76:77], s67, v231
    s_nop 0
    s_or_b64 vcc, vcc, s[76:77]
    v_cmp_ne_u32 s[76:77], s67, v233
    s_nop 0
    s_or_b64 vcc, vcc, s[76:77]
    s_nop 0
    s_cbranch_vccz Lok_36
    s_mov_b32 s68, 200000
Lspin_35:
    buffer_load_dwordx4 v[228:231], v2, s[20:23], s71 offen sc1
    buffer_load_dwordx2 v[232:233], v3, s[20:23], s73 offen sc1
    s_waitcnt vmcnt(0)
    v_cmp_ne_u32 vcc, s67, v229
    v_cmp_ne_u32 s[76:77], s67, v231
    s_nop 0
    s_or_b64 vcc, vcc, s[76:77]
    v_cmp_ne_u32 s[76:77], s67, v233
    s_nop 0
    s_or_b64 vcc, vcc, s[76:77]
    s_nop 0
    s_cbranch_vccz Lok_36
    s_sleep 2
    s_sub_u32 s68, s68, 1
    s_cmp_lg_u32 s68, 0
    s_cbranch_scc1 Lspin_35
Lok_36:
    v_add_f32 v228, v228, v242
    v_add_f32 v230, v230, v243
    s_nop 0
    v_mfma_f32_16x16x1_4b_f32 v[4:19], v228, v232, v[4:19] cbsz:2 abid:0
    v_mfma_f32_16x16x1_4b_f32 v[68:83], v230, v232, v[68:83] cbsz:2 abid:0
    v_mfma_f32_16x16x1_4b_f32 v[20:35], v228, v232, v[20:35] cbsz:2 abid:1
    v_mfma_f32_16x16x1_4b_f32 v[84:99], v230, v232, v[84:99] cbsz:2 abid:1
    v_mfma_f32_16x16x1_4b_f32 v[36:51], v228, v232, v[36:51] cbsz:2 abid:2
    v_mfma_f32_16x16x1_4b_f32 v[100:115], v230, v232, v[100:115] cbsz:2 abid:2
    v_mfma_f32_16x16x1_4b_f32 v[52:67], v228, v232, v[52:67] cbsz:2 abid:3
    v_mfma_f32_16x16x1_4b_f32 v[116:131], v230, v232, v[116:131] cbsz:2 abid:3
    s_lshl_b32 s70, s59, 2
    v_mov_b32 v239, s70
    v_mov_b32 v240, s67
    ds_write_b32 v239, v240 offset:32400
    s_add_u32 s72, s74, 4096
    v_max_f32 v4, 0, v4
    v_max_f32 v5, 0, v5
    v_max_f32 v6, 0, v6
    v_max_f32 v7, 0, v7
    v_max_f32 v20, 0, v20
    v_max_f32 v21, 0, v21
    v_max_f32 v22, 0, v22
    v_max_f32 v23, 0, v23
    v_mul_f32 v68, v4, v68
    v_mul_f32 v69, v5, v69
    v_mul_f32 v70, v6, v70
    v_mul_f32 v71, v7, v71
    v_mul_f32 v84, v20, v84
    v_mul_f32 v85, v21, v85
    v_mul_f32 v86, v22, v86
    v_mul_f32 v87, v23, v87
    v_cvt_pk_bf16_f32 v4, v68, v69
    v_cvt_pk_bf16_f32 v5, v70, v71
    v_cvt_pk_bf16_f32 v6, v84, v85
    v_cvt_pk_bf16_f32 v7, v86, v87
    buffer_store_dwordx4 v[4:7], v2, s[20:23], s74 offen offset:0 sc1
    v_max_f32 v8, 0, v8
    v_max_f32 v9, 0, v9
    v_max_f32 v10, 0, v10
    v_max_f32 v11, 0, v11
    v_max_f32 v24, 0, v24
    v_max_f32 v25, 0, v25
    v_max_f32 v26, 0, v26
    v_max_f32 v27, 0, v27
    v_mul_f32 v72, v8, v72
    v_mul_f32 v73, v9, v73
    v_mul_f32 v74, v10, v74
    v_mul_f32 v75, v11, v75
    v_mul_f32 v88, v24, v88
    v_mul_f32 v89, v25, v89
    v_mul_f32 v90, v26, v90
    v_mul_f32 v91, v27, v91
    v_cvt_pk_bf16_f32 v8, v72, v73
    v_cvt_pk_bf16_f32 v9, v74, v75
    v_cvt_pk_bf16_f32 v10, v88, v89
    v_cvt_pk_bf16_f32 v11, v90, v91
    buffer_store_dwordx4 v[8:11], v2, s[20:23], s74 offen offset:1024 sc1
    v_max_f32 v12, 0, v12
    v_max_f32 v13, 0, v13
    v_max_f32 v14, 0, v14
    v_max_f32 v15, 0, v15
    v_max_f32 v28, 0, v28
    v_max_f32 v29, 0, v29
    v_max_f32 v30, 0, v30
    v_max_f32 v31, 0, v31
    v_mul_f32 v76, v12, v76
    v_mul_f32 v77, v13, v77
    v_mul_f32 v78, v14, v78
    v_mul_f32 v79, v15, v79
    v_mul_f32 v92, v28, v92
    v_mul_f32 v93, v29, v93
    v_mul_f32 v94, v30, v94
    v_mul_f32 v95, v31, v95
    v_cvt_pk_bf16_f32 v12, v76, v77
    v_cvt_pk_bf16_f32 v13, v78, v79
    v_cvt_pk_bf16_f32 v14, v92, v93
    v_cvt_pk_bf16_f32 v15, v94, v95
    buffer_store_dwordx4 v[12:15], v2, s[20:23], s74 offen offset:2048 sc1
    v_max_f32 v16, 0, v16
    v_max_f32 v17, 0, v17
    v_max_f32 v18, 0, v18
    v_max_f32 v19, 0, v19
    v_max_f32 v32, 0, v32
    v_max_f32 v33, 0, v33
    v_max_f32 v34, 0, v34
    v_max_f32 v35, 0, v35
    v_mul_f32 v80, v16, v80
    v_mul_f32 v81, v17, v81
    v_mul_f32 v82, v18, v82
    v_mul_f32 v83, v19, v83
    v_mul_f32 v96, v32, v96
    v_mul_f32 v97, v33, v97
    v_mul_f32 v98, v34, v98
    v_mul_f32 v99, v35, v99
    v_cvt_pk_bf16_f32 v16, v80, v81
    v_cvt_pk_bf16_f32 v17, v82, v83
    v_cvt_pk_bf16_f32 v18, v96, v97
    v_cvt_pk_bf16_f32 v19, v98, v99
    buffer_store_dwordx4 v[16:19], v2, s[20:23], s74 offen offset:3072 sc1
    v_max_f32 v36, 0, v36
    v_max_f32 v37, 0, v37
    v_max_f32 v38, 0, v38
    v_max_f32 v39, 0, v39
    v_max_f32 v52, 0, v52
    v_max_f32 v53, 0, v53
    v_max_f32 v54, 0, v54
    v_max_f32 v55, 0, v55
    v_mul_f32 v100, v36, v100
    v_mul_f32 v101, v37, v101
    v_mul_f32 v102, v38, v102
    v_mul_f32 v103, v39, v103
    v_mul_f32 v116, v52, v116
    v_mul_f32 v117, v53, v117
    v_mul_f32 v118, v54, v118
    v_mul_f32 v119, v55, v119
    v_cvt_pk_bf16_f32 v36, v100, v101
    v_cvt_pk_bf16_f32 v37, v102, v103
    v_cvt_pk_bf16_f32 v38, v116, v117
    v_cvt_pk_bf16_f32 v39, v118, v119
    buffer_store_dwordx4 v[36:39], v2, s[20:23], s72 offen offset:0 sc1
    v_max_f32 v40, 0, v40
    v_max_f32 v41, 0, v41
    v_max_f32 v42, 0, v42
    v_max_f32 v43, 0, v43
    v_max_f32 v56, 0, v56
    v_max_f32 v57, 0, v57
    v_max_f32 v58, 0, v58
    v_max_f32 v59, 0, v59
    v_mul_f32 v104, v40, v104
    v_mul_f32 v105, v41, v105
    v_mul_f32 v106, v42, v106
    v_mul_f32 v107, v43, v107
    v_mul_f32 v120, v56, v120
    v_mul_f32 v121, v57, v121
    v_mul_f32 v122, v58, v122
    v_mul_f32 v123, v59, v123
    v_cvt_pk_bf16_f32 v40, v104, v105
    v_cvt_pk_bf16_f32 v41, v106, v107
    v_cvt_pk_bf16_f32 v42, v120, v121
    v_cvt_pk_bf16_f32 v43, v122, v123
    buffer_store_dwordx4 v[40:43], v2, s[20:23], s72 offen offset:1024 sc1
    v_max_f32 v44, 0, v44
    v_max_f32 v45, 0, v45
    v_max_f32 v46, 0, v46
    v_max_f32 v47, 0, v47
    v_max_f32 v60, 0, v60
    v_max_f32 v61, 0, v61
    v_max_f32 v62, 0, v62
    v_max_f32 v63, 0, v63
    v_mul_f32 v108, v44, v108
    v_mul_f32 v109, v45, v109
    v_mul_f32 v110, v46, v110
    v_mul_f32 v111, v47, v111
    v_mul_f32 v124, v60, v124
    v_mul_f32 v125, v61, v125
    v_mul_f32 v126, v62, v126
    v_mul_f32 v127, v63, v127
    v_cvt_pk_bf16_f32 v44, v108, v109
    v_cvt_pk_bf16_f32 v45, v110, v111
    v_cvt_pk_bf16_f32 v46, v124, v125
    v_cvt_pk_bf16_f32 v47, v126, v127
    buffer_store_dwordx4 v[44:47], v2, s[20:23], s72 offen offset:2048 sc1
    v_max_f32 v48, 0, v48
    v_max_f32 v49, 0, v49
    v_max_f32 v50, 0, v50
    v_max_f32 v51, 0, v51
    v_max_f32 v64, 0, v64
    v_max_f32 v65, 0, v65
    v_max_f32 v66, 0, v66
    v_max_f32 v67, 0, v67
    v_mul_f32 v112, v48, v112
    v_mul_f32 v113, v49, v113
    v_mul_f32 v114, v50, v114
    v_mul_f32 v115, v51, v115
    v_mul_f32 v128, v64, v128
    v_mul_f32 v129, v65, v129
    v_mul_f32 v130, v66, v130
    v_mul_f32 v131, v67, v131
    v_cvt_pk_bf16_f32 v48, v112, v113
    v_cvt_pk_bf16_f32 v49, v114, v115
    v_cvt_pk_bf16_f32 v50, v128, v129
    v_cvt_pk_bf16_f32 v51, v130, v131
    buffer_store_dwordx4 v[48:51], v2, s[20:23], s72 offen offset:3072 sc1
    s_lshr_b32 s71, s63, 1
    s_lshl_b32 s71, s71, 11
    s_add_u32 s70, s71, 14876672
    v_lshrrev_b32 v3, 2, v1
    v_min_u32 v3, 13, v3
    v_lshl_add_u32 v3, v3, 7, s70
    v_add_u32 v244, 32768, v244
    v_add_u32 v248, 0x10000, v244
    v_add_u32 v245, 32768, v245
    v_add_u32 v249, 0x10000, v245
    v_add_u32 v246, 32768, v246
    v_add_u32 v250, 0x10000, v246
    v_add_u32 v247, 32768, v247
    v_add_u32 v251, 0x10000, v247
    v_add_u32 v252, 6144, v0
    v_add_u32 v253, 12288, v0
    v_add_u32 v254, 18432, v0
    s_lshl_b32 s70, s59, 2
    v_mov_b32 v68, s70
    s_mov_b32 s68, 2000000
Lab_37:
    ds_read_b32 v69, v68 offset:32256
    s_waitcnt lgkmcnt(0)
    v_cmp_ne_u32 vcc, s67, v69
    s_sub_u32 s68, s68, 1
    s_nop 3
    s_cbranch_vccz Lae_38
    s_cmp_lg_u32 s68, 0
    s_cbranch_scc1 Lab_37
Lae_38:
    ds_read_b64_tr_b16 v[132:133], v244 offset:0
    ds_read_b64_tr_b16 v[134:135], v244 offset:2048
    ds_read_b64_tr_b16 v[136:137], v245 offset:0
    ds_read_b64_tr_b16 v[138:139], v245 offset:2048
    ds_read_b64_tr_b16 v[140:141], v246 offset:0
    ds_read_b64_tr_b16 v[142:143], v246 offset:2048
    ds_read_b64_tr_b16 v[144:145], v247 offset:0
    ds_read_b64_tr_b16 v[146:147], v247 offset:2048
    ds_read_b64_tr_b16 v[148:149], v244 offset:16384
    ds_read_b64_tr_b16 v[150:151], v244 offset:18432
    ds_read_b64_tr_b16 v[152:153], v245 offset:16384
    ds_read_b64_tr_b16 v[154:155], v245 offset:18432
    ds_read_b64_tr_b16 v[156:157], v246 offset:16384
    ds_read_b64_tr_b16 v[158:159], v246 offset:18432
    ds_read_b64_tr_b16 v[160:161], v247 offset:16384
    ds_read_b64_tr_b16 v[162:163], v247 offset:18432
    s_waitcnt vmcnt(0)
    s_lshl_b32 s70, s59, 2
    v_mov_b32 v68, s70
    v_mov_b32 v69, s67
    ds_write_b32 v68, v69 offset:32336
    v_and_b32 v68, 3, v1
    v_lshlrev_b32 v68, 2, v68
    s_mov_b32 s68, 2000000
Lab_39:
    ds_read_b32 v69, v68 offset:32336
    s_waitcnt lgkmcnt(0)
    v_cmp_ne_u32 vcc, s67, v69
    s_sub_u32 s68, s68, 1
    s_nop 3
    s_cbranch_vccz Lae_40
    s_cmp_lg_u32 s68, 0
    s_cbranch_scc1 Lab_39
Lae_40:
    s_cmp_lg_u32 s60, 0
    s_cbranch_scc1 Lg_41
    v_mov_b32 v255, s67
    v_lshlrev_b32 v68, 2, v1
    s_mov_b32 exec_hi, 0
    buffer_store_dword v255, v68, s[20:23], s75 offen sc1
    s_mov_b32 exec_hi, -1
Lg_41:
    v_and_b32 v68, 3, v1
    v_lshlrev_b32 v68, 2, v68
    s_mov_b32 s68, 2000000
Lab_42:
    ds_read_b32 v69, v68 offset:32288
    s_waitcnt lgkmcnt(0)
    v_cmp_ne_u32 vcc, s67, v69
    s_sub_u32 s68, s68, 1
    s_nop 3
    s_cbranch_vccz Lae_43
    s_cmp_lg_u32 s68, 0
    s_cbranch_scc1 Lab_42
Lae_43:
    s_setprio 0
    s_add_u32 m0, s52, 32768
    s_mul_i32 s70, s34, 57344
    s_add_u32 s70, s70, s51
    buffer_load_dwordx4 v0, s[16:19], s70 offen offset:0 lds
    buffer_load_dwordx4 v252, s[16:19], s70 offen offset:1024 lds
    buffer_load_dwordx4 v253, s[16:19], s70 offen offset:2048 lds
    buffer_load_dwordx4 v254, s[16:19], s70 offen offset:3072 lds
    s_add_u32 m0, s52, 49152
    s_mul_i32 s70, s34, 57344
    s_add_u32 s70, s70, s51
    s_add_u32 s70, s70, 28672
    buffer_load_dwordx4 v0, s[16:19], s70 offen offset:0 lds
    buffer_load_dwordx4 v252, s[16:19], s70 offen offset:1024 lds
    buffer_load_dwordx4 v253, s[16:19], s70 offen offset:2048 lds
    buffer_load_dwordx4 v254, s[16:19], s70 offen offset:3072 lds
    s_add_u32 m0, s52, 65536
    s_mul_i32 s70, s35, 57344
    s_add_u32 s70, s70, s51
    buffer_load_dwordx4 v0, s[16:19], s70 offen offset:0 lds
    buffer_load_dwordx4 v252, s[16:19], s70 offen offset:1024 lds
    buffer_load_dwordx4 v253, s[16:19], s70 offen offset:2048 lds
    buffer_load_dwordx4 v254, s[16:19], s70 offen offset:3072 lds
    s_add_u32 m0, s52, 81920
    s_mul_i32 s70, s35, 57344
    s_add_u32 s70, s70, s51
    s_add_u32 s70, s70, 28672
    buffer_load_dwordx4 v0, s[16:19], s70 offen offset:0 lds
    buffer_load_dwordx4 v252, s[16:19], s70 offen offset:1024 lds
    buffer_load_dwordx4 v253, s[16:19], s70 offen offset:2048 lds
    buffer_load_dwordx4 v254, s[16:19], s70 offen offset:3072 lds
    s_add_u32 m0, s52, 98304
    s_mul_i32 s70, s36, 57344
    s_add_u32 s70, s70, s51
    buffer_load_dwordx4 v0, s[16:19], s70 offen offset:0 lds
    buffer_load_dwordx4 v252, s[16:19], s70 offen offset:1024 lds
    buffer_load_dwordx4 v253, s[16:19], s70 offen offset:2048 lds
    buffer_load_dwordx4 v254, s[16:19], s70 offen offset:3072 lds
    s_cmp_lg_u32 s60, 0
    s_cbranch_scc1 Lg_44
    buffer_load_dword v255, v3, s[20:23], 0 offen sc1
Lg_44:
    s_add_u32 m0, s52, 0
    s_mul_i32 s70, s36, 57344
    s_add_u32 s70, s70, s51
    s_add_u32 s70, s70, 28672
    buffer_load_dwordx4 v0, s[16:19], s70 offen offset:0 lds
    buffer_load_dwordx4 v252, s[16:19], s70 offen offset:1024 lds
    buffer_load_dwordx4 v253, s[16:19], s70 offen offset:2048 lds
    buffer_load_dwordx4 v254, s[16:19], s70 offen offset:3072 lds
    s_add_u32 m0, s52, 16384
    s_mul_i32 s70, s37, 57344
    s_add_u32 s70, s70, s51
    buffer_load_dwordx4 v0, s[16:19], s70 offen offset:0 lds
    buffer_load_dwordx4 v252, s[16:19], s70 offen offset:1024 lds
    buffer_load_dwordx4 v253, s[16:19], s70 offen offset:2048 lds
    buffer_load_dwordx4 v254, s[16:19], s70 offen offset:3072 lds
    s_waitcnt vmcnt(24)
    ds_read_b64_tr_b16 v[164:165], v244 offset:32768
    ds_read_b64_tr_b16 v[166:167], v244 offset:34816
    ds_read_b64_tr_b16 v[168:169], v245 offset:32768
    ds_read_b64_tr_b16 v[170:171], v245 offset:34816
    ds_read_b64_tr_b16 v[172:173], v246 offset:32768
    ds_read_b64_tr_b16 v[174:175], v246 offset:34816
    ds_read_b64_tr_b16 v[176:177], v247 offset:32768
    ds_read_b64_tr_b16 v[178:179], v247 offset:34816
    s_waitcnt lgkmcnt(0)
    s_add_u32 m0, s52, 32768
    s_mul_i32 s70, s37, 57344
    s_add_u32 s70, s70, s51
    s_add_u32 s70, s70, 28672
    buffer_load_dwordx4 v0, s[16:19], s70 offen offset:0 lds
    buffer_load_dwordx4 v252, s[16:19], s70 offen offset:1024 lds
    buffer_load_dwordx4 v253, s[16:19], s70 offen offset:2048 lds
    buffer_load_dwordx4 v254, s[16:19], s70 offen offset:3072 lds
    s_cmp_lg_u32 s60, 0
    s_cbranch_scc1 Lg_45
    s_waitcnt vmcnt(12)
    v_cmp_ne_u32 vcc, s67, v255
    s_nop 4
    s_cbranch_vccz Lok_48
    s_mov_b32 s68, 200000
Lspin_47:
    buffer_load_dword v255, v3, s[20:23], 0 offen sc1
    s_waitcnt vmcnt(0)
    v_cmp_ne_u32 vcc, s67, v255
    s_nop 4
    s_cbranch_vccz Lok_48
    s_sleep 1
    s_sub_u32 s68, s68, 1
    s_cmp_lg_u32 s68, 0
    s_cbranch_scc1 Lspin_47
Lok_48:
    s_lshl_b32 s70, s59, 2
    v_mov_b32 v68, s70
    v_mov_b32 v69, s67
    ds_write_b32 v68, v69 offset:32352
    s_branch Lg_46
Lg_45:
    v_mov_b32 v68, 0
    s_mov_b32 s68, 2000000
Lab_49:
    ds_read_b32 v69, v68 offset:32352
    s_waitcnt lgkmcnt(0)
    v_cmp_ne_u32 vcc, s67, v69
    s_sub_u32 s68, s68, 1
    s_nop 3
    s_cbranch_vccz Lae_50
    s_cmp_lg_u32 s68, 0
    s_cbranch_scc1 Lab_49
Lae_50:
Lg_46:
    s_mul_i32 s73, s32, 8192
    s_add_u32 s73, s73, s50
    buffer_load_dwordx4 v[180:183], v2, s[20:23], s73 offen offset:0 sc1
    buffer_load_dwordx4 v[184:187], v2, s[20:23], s73 offen offset:1024 sc1
    buffer_load_dwordx4 v[188:191], v2, s[20:23], s73 offen offset:2048 sc1
    buffer_load_dwordx4 v[192:195], v2, s[20:23], s73 offen offset:3072 sc1
    s_mul_i32 s73, s32, 8192
    s_add_u32 s73, s73, s50
    s_add_u32 s73, s73, 4096
    buffer_load_dwordx4 v[228:231], v2, s[20:23], s73 offen offset:0 sc1
    buffer_load_dwordx4 v[232:235], v2, s[20:23], s73 offen offset:1024 sc1
    buffer_load_dwordx4 v[236:239], v2, s[20:23], s73 offen offset:2048 sc1
    buffer_load_dwordx4 v[240:243], v2, s[20:23], s73 offen offset:3072 sc1
    s_mul_i32 s73, s33, 8192
    s_add_u32 s73, s73, s50
    buffer_load_dwordx4 v[4:7], v2, s[20:23], s73 offen offset:0 sc1
    buffer_load_dwordx4 v[8:11], v2, s[20:23], s73 offen offset:1024 sc1
    buffer_load_dwordx4 v[12:15], v2, s[20:23], s73 offen offset:2048 sc1
    buffer_load_dwordx4 v[16:19], v2, s[20:23], s73 offen offset:3072 sc1
    s_mul_i32 s73, s33, 8192
    s_add_u32 s73, s73, s50
    s_add_u32 s73, s73, 4096
    buffer_load_dwordx4 v[20:23], v2, s[20:23], s73 offen offset:0 sc1
    buffer_load_dwordx4 v[24:27], v2, s[20:23], s73 offen offset:1024 sc1
    buffer_load_dwordx4 v[28:31], v2, s[20:23], s73 offen offset:2048 sc1
    buffer_load_dwordx4 v[32:35], v2, s[20:23], s73 offen offset:3072 sc1
    s_mul_i32 s73, s34, 8192
    s_add_u32 s73, s73, s50
    buffer_load_dwordx4 v[36:39], v2, s[20:23], s73 offen offset:0 sc1
    buffer_load_dwordx4 v[40:43], v2, s[20:23], s73 offen offset:1024 sc1
    buffer_load_dwordx4 v[44:47], v2, s[20:23], s73 offen offset:2048 sc1
    buffer_load_dwordx4 v[48:51], v2, s[20:23], s73 offen offset:3072 sc1
    s_mul_i32 s73, s34, 8192
    s_add_u32 s73, s73, s50
    s_add_u32 s73, s73, 4096
    buffer_load_dwordx4 v[52:55], v2, s[20:23], s73 offen offset:0 sc1
    buffer_load_dwordx4 v[56:59], v2, s[20:23], s73 offen offset:1024 sc1
    buffer_load_dwordx4 v[60:63], v2, s[20:23], s73 offen offset:2048 sc1
    buffer_load_dwordx4 v[64:67], v2, s[20:23], s73 offen offset:3072 sc1
    s_waitcnt vmcnt(20)
    v_mfma_f32_16x16x32_bf16 v[68:71], v[196:199], v[180:183], 0
    v_mfma_f32_16x16x32_bf16 v[72:75], v[200:203], v[180:183], 0
    v_mfma_f32_16x16x32_bf16 v[76:79], v[204:207], v[180:183], 0
    v_mfma_f32_16x16x32_bf16 v[80:83], v[208:211], v[180:183], 0
    v_mfma_f32_16x16x32_bf16 v[84:87], v[196:199], v[184:187], 0
    v_mfma_f32_16x16x32_bf16 v[88:91], v[200:203], v[184:187], 0
    v_mfma_f32_16x16x32_bf16 v[92:95], v[204:207], v[184:187], 0
    v_mfma_f32_16x16x32_bf16 v[96:99], v[208:211], v[184:187], 0
    v_mfma_f32_16x16x32_bf16 v[100:103], v[196:199], v[188:191], 0
    v_mfma_f32_16x16x32_bf16 v[104:107], v[200:203], v[188:191], 0
    v_mfma_f32_16x16x32_bf16 v[108:111], v[204:207], v[188:191], 0
    v_mfma_f32_16x16x32_bf16 v[112:115], v[208:211], v[188:191], 0
    v_mfma_f32_16x16x32_bf16 v[116:119], v[196:199], v[192:195], 0
    v_mfma_f32_16x16x32_bf16 v[120:123], v[200:203], v[192:195], 0
    v_mfma_f32_16x16x32_bf16 v[124:127], v[204:207], v[192:195], 0
    v_mfma_f32_16x16x32_bf16 v[128:131], v[208:211], v[192:195], 0
    s_waitcnt vmcnt(16)
    v_mfma_f32_16x16x32_bf16 v[68:71], v[212:215], v[228:231], v[68:71]
    v_mfma_f32_16x16x32_bf16 v[72:75], v[216:219], v[228:231], v[72:75]
    v_mfma_f32_16x16x32_bf16 v[76:79], v[220:223], v[228:231], v[76:79]
    v_mfma_f32_16x16x32_bf16 v[80:83], v[224:227], v[228:231], v[80:83]
    v_mfma_f32_16x16x32_bf16 v[84:87], v[212:215], v[232:235], v[84:87]
    v_mfma_f32_16x16x32_bf16 v[88:91], v[216:219], v[232:235], v[88:91]
    v_mfma_f32_16x16x32_bf16 v[92:95], v[220:223], v[232:235], v[92:95]
    v_mfma_f32_16x16x32_bf16 v[96:99], v[224:227], v[232:235], v[96:99]
    v_mfma_f32_16x16x32_bf16 v[100:103], v[212:215], v[236:239], v[100:103]
    v_mfma_f32_16x16x32_bf16 v[104:107], v[216:219], v[236:239], v[104:107]
    v_mfma_f32_16x16x32_bf16 v[108:111], v[220:223], v[236:239], v[108:111]
    v_mfma_f32_16x16x32_bf16 v[112:115], v[224:227], v[236:239], v[112:115]
    v_mfma_f32_16x16x32_bf16 v[116:119], v[212:215], v[240:243], v[116:119]
    v_mfma_f32_16x16x32_bf16 v[120:123], v[216:219], v[240:243], v[120:123]
    v_mfma_f32_16x16x32_bf16 v[124:127], v[220:223], v[240:243], v[124:127]
    v_mfma_f32_16x16x32_bf16 v[128:131], v[224:227], v[240:243], v[128:131]
    s_waitcnt vmcnt(12)
    v_mfma_f32_16x16x32_bf16 v[68:71], v[132:135], v[4:7], v[68:71]
    v_mfma_f32_16x16x32_bf16 v[72:75], v[136:139], v[4:7], v[72:75]
    s_mul_i32 s73, s35, 8192
    v_mfma_f32_16x16x32_bf16 v[76:79], v[140:143], v[4:7], v[76:79]
    v_mfma_f32_16x16x32_bf16 v[80:83], v[144:147], v[4:7], v[80:83]
    s_add_u32 s73, s73, s50
    v_mfma_f32_16x16x32_bf16 v[84:87], v[132:135], v[8:11], v[84:87]
    v_mfma_f32_16x16x32_bf16 v[88:91], v[136:139], v[8:11], v[88:91]
    buffer_load_dwordx4 v[196:199], v2, s[20:23], s73 offen offset:0 sc1
    v_mfma_f32_16x16x32_bf16 v[92:95], v[140:143], v[8:11], v[92:95]
    v_mfma_f32_16x16x32_bf16 v[96:99], v[144:147], v[8:11], v[96:99]
    buffer_load_dwordx4 v[200:203], v2, s[20:23], s73 offen offset:1024 sc1
    v_mfma_f32_16x16x32_bf16 v[100:103], v[132:135], v[12:15], v[100:103]
    v_mfma_f32_16x16x32_bf16 v[104:107], v[136:139], v[12:15], v[104:107]
    buffer_load_dwordx4 v[204:207], v2, s[20:23], s73 offen offset:2048 sc1
    v_mfma_f32_16x16x32_bf16 v[108:111], v[140:143], v[12:15], v[108:111]
    v_mfma_f32_16x16x32_bf16 v[112:115], v[144:147], v[12:15], v[112:115]
    buffer_load_dwordx4 v[208:211], v2, s[20:23], s73 offen offset:3072 sc1
    v_mfma_f32_16x16x32_bf16 v[116:119], v[132:135], v[16:19], v[116:119]
    v_mfma_f32_16x16x32_bf16 v[120:123], v[136:139], v[16:19], v[120:123]
    v_mfma_f32_16x16x32_bf16 v[124:127], v[140:143], v[16:19], v[124:127]
    v_mfma_f32_16x16x32_bf16 v[128:131], v[144:147], v[16:19], v[128:131]
    s_waitcnt vmcnt(12)
    v_mfma_f32_16x16x32_bf16 v[68:71], v[148:151], v[20:23], v[68:71]
    ds_read_b64_tr_b16 v[180:181], v244 offset:49152
    v_mfma_f32_16x16x32_bf16 v[72:75], v[152:155], v[20:23], v[72:75]
    s_mul_i32 s73, s35, 8192
    v_mfma_f32_16x16x32_bf16 v[76:79], v[156:159], v[20:23], v[76:79]
    ds_read_b64_tr_b16 v[182:183], v244 offset:51200
    v_mfma_f32_16x16x32_bf16 v[80:83], v[160:163], v[20:23], v[80:83]
    s_add_u32 s73, s73, s50
    v_mfma_f32_16x16x32_bf16 v[84:87], v[148:151], v[24:27], v[84:87]
    ds_read_b64_tr_b16 v[184:185], v245 offset:49152
    v_mfma_f32_16x16x32_bf16 v[88:91], v[152:155], v[24:27], v[88:91]
    s_add_u32 s73, s73, 4096
    v_mfma_f32_16x16x32_bf16 v[92:95], v[156:159], v[24:27], v[92:95]
    ds_read_b64_tr_b16 v[186:187], v245 offset:51200
    v_mfma_f32_16x16x32_bf16 v[96:99], v[160:163], v[24:27], v[96:99]
    buffer_load_dwordx4 v[212:215], v2, s[20:23], s73 offen offset:0 sc1
    v_mfma_f32_16x16x32_bf16 v[100:103], v[148:151], v[28:31], v[100:103]
    ds_read_b64_tr_b16 v[188:189], v246 offset:49152
    v_mfma_f32_16x16x32_bf16 v[104:107], v[152:155], v[28:31], v[104:107]
    buffer_load_dwordx4 v[216:219], v2, s[20:23], s73 offen offset:1024 sc1
    v_mfma_f32_16x16x32_bf16 v[108:111], v[156:159], v[28:31], v[108:111]
    ds_read_b64_tr_b16 v[190:191], v246 offset:51200
    v_mfma_f32_16x16x32_bf16 v[112:115], v[160:163], v[28:31], v[112:115]
    buffer_load_dwordx4 v[220:223], v2, s[20:23], s73 offen offset:2048 sc1
    v_mfma_f32_16x16x32_bf16 v[116:119], v[148:151], v[32:35], v[116:119]
    ds_read_b64_tr_b16 v[192:193], v247 offset:49152
    v_mfma_f32_16x16x32_bf16 v[120:123], v[152:155], v[32:35], v[120:123]
    buffer_load_dwordx4 v[224:227], v2, s[20:23], s73 offen offset:3072 sc1
    v_mfma_f32_16x16x32_bf16 v[124:127], v[156:159], v[32:35], v[124:127]
    ds_read_b64_tr_b16 v[194:195], v247 offset:51200
    v_mfma_f32_16x16x32_bf16 v[128:131], v[160:163], v[32:35], v[128:131]
    s_waitcnt vmcnt(12)
    v_mfma_f32_16x16x32_bf16 v[68:71], v[164:167], v[36:39], v[68:71]
    ds_read_b64_tr_b16 v[228:229], v248 offset:0
    v_mfma_f32_16x16x32_bf16 v[72:75], v[168:171], v[36:39], v[72:75]
    s_mul_i32 s73, s36, 8192
    v_mfma_f32_16x16x32_bf16 v[76:79], v[172:175], v[36:39], v[76:79]
    ds_read_b64_tr_b16 v[230:231], v248 offset:2048
    v_mfma_f32_16x16x32_bf16 v[80:83], v[176:179], v[36:39], v[80:83]
    s_add_u32 s73, s73, s50
    v_mfma_f32_16x16x32_bf16 v[84:87], v[164:167], v[40:43], v[84:87]
    ds_read_b64_tr_b16 v[232:233], v249 offset:0
    v_mfma_f32_16x16x32_bf16 v[88:91], v[168:171], v[40:43], v[88:91]
    buffer_load_dwordx4 v[132:135], v2, s[20:23], s73 offen offset:0 sc1
    v_mfma_f32_16x16x32_bf16 v[92:95], v[172:175], v[40:43], v[92:95]
    ds_read_b64_tr_b16 v[234:235], v249 offset:2048
    v_mfma_f32_16x16x32_bf16 v[96:99], v[176:179], v[40:43], v[96:99]
    buffer_load_dwordx4 v[136:139], v2, s[20:23], s73 offen offset:1024 sc1
    v_mfma_f32_16x16x32_bf16 v[100:103], v[164:167], v[44:47], v[100:103]
    ds_read_b64_tr_b16 v[236:237], v250 offset:0
    v_mfma_f32_16x16x32_bf16 v[104:107], v[168:171], v[44:47], v[104:107]
    buffer_load_dwordx4 v[140:143], v2, s[20:23], s73 offen offset:2048 sc1
    v_mfma_f32_16x16x32_bf16 v[108:111], v[172:175], v[44:47], v[108:111]
    ds_read_b64_tr_b16 v[238:239], v250 offset:2048
    v_mfma_f32_16x16x32_bf16 v[112:115], v[176:179], v[44:47], v[112:115]
    buffer_load_dwordx4 v[144:147], v2, s[20:23], s73 offen offset:3072 sc1
    v_mfma_f32_16x16x32_bf16 v[116:119], v[164:167], v[48:51], v[116:119]
    ds_read_b64_tr_b16 v[240:241], v251 offset:0
    v_mfma_f32_16x16x32_bf16 v[120:123], v[168:171], v[48:51], v[120:123]
    v_mfma_f32_16x16x32_bf16 v[124:127], v[172:175], v[48:51], v[124:127]
    ds_read_b64_tr_b16 v[242:243], v251 offset:2048
    v_mfma_f32_16x16x32_bf16 v[128:131], v[176:179], v[48:51], v[128:131]
    s_waitcnt vmcnt(12)
    s_waitcnt lgkmcnt(8)
    v_mfma_f32_16x16x32_bf16 v[68:71], v[180:183], v[52:55], v[68:71]
    ds_read_b64_tr_b16 v[4:5], v248 offset:16384
    v_mfma_f32_16x16x32_bf16 v[72:75], v[184:187], v[52:55], v[72:75]
    s_mul_i32 s73, s36, 8192
    v_mfma_f32_16x16x32_bf16 v[76:79], v[188:191], v[52:55], v[76:79]
    ds_read_b64_tr_b16 v[6:7], v248 offset:18432
    v_mfma_f32_16x16x32_bf16 v[80:83], v[192:195], v[52:55], v[80:83]
    s_add_u32 s73, s73, s50
    v_mfma_f32_16x16x32_bf16 v[84:87], v[180:183], v[56:59], v[84:87]
    ds_read_b64_tr_b16 v[8:9], v249 offset:16384
    v_mfma_f32_16x16x32_bf16 v[88:91], v[184:187], v[56:59], v[88:91]
    s_add_u32 s73, s73, 4096
    v_mfma_f32_16x16x32_bf16 v[92:95], v[188:191], v[56:59], v[92:95]
    ds_read_b64_tr_b16 v[10:11], v249 offset:18432
    v_mfma_f32_16x16x32_bf16 v[96:99], v[192:195], v[56:59], v[96:99]
    buffer_load_dwordx4 v[148:151], v2, s[20:23], s73 offen offset:0 sc1
    v_mfma_f32_16x16x32_bf16 v[100:103], v[180:183], v[60:63], v[100:103]
    ds_read_b64_tr_b16 v[12:13], v250 offset:16384
    v_mfma_f32_16x16x32_bf16 v[104:107], v[184:187], v[60:63], v[104:107]
    buffer_load_dwordx4 v[152:155], v2, s[20:23], s73 offen offset:1024 sc1
    v_mfma_f32_16x16x32_bf16 v[108:111], v[188:191], v[60:63], v[108:111]
    ds_read_b64_tr_b16 v[14:15], v250 offset:18432
    v_mfma_f32_16x16x32_bf16 v[112:115], v[192:195], v[60:63], v[112:115]
    buffer_load_dwordx4 v[156:159], v2, s[20:23], s73 offen offset:2048 sc1
    v_mfma_f32_16x16x32_bf16 v[116:119], v[180:183], v[64:67], v[116:119]
    ds_read_b64_tr_b16 v[16:17], v251 offset:16384
    v_mfma_f32_16x16x32_bf16 v[120:123], v[184:187], v[64:67], v[120:123]
    buffer_load_dwordx4 v[160:163], v2, s[20:23], s73 offen offset:3072 sc1
    v_mfma_f32_16x16x32_bf16 v[124:127], v[188:191], v[64:67], v[124:127]
    ds_read_b64_tr_b16 v[18:19], v251 offset:18432
    v_mfma_f32_16x16x32_bf16 v[128:131], v[192:195], v[64:67], v[128:131]
    s_waitcnt vmcnt(12)
    s_waitcnt lgkmcnt(8)
    s_lshl_b32 s70, s59, 2
    v_mov_b32 v36, s70
    v_mov_b32 v37, s67
    ds_write_b32 v36, v37 offset:32320
    v_mfma_f32_16x16x32_bf16 v[68:71], v[228:231], v[196:199], v[68:71]
    ds_read_b64_tr_b16 v[20:21], v248 offset:32768
    v_mfma_f32_16x16x32_bf16 v[72:75], v[232:235], v[196:199], v[72:75]
    s_mul_i32 s73, s37, 8192
    v_mfma_f32_16x16x32_bf16 v[76:79], v[236:239], v[196:199], v[76:79]
    ds_read_b64_tr_b16 v[22:23], v248 offset:34816
    v_mfma_f32_16x16x32_bf16 v[80:83], v[240:243], v[196:199], v[80:83]
    s_add_u32 s73, s73, s50
    v_mfma_f32_16x16x32_bf16 v[84:87], v[228:231], v[200:203], v[84:87]
    ds_read_b64_tr_b16 v[24:25], v249 offset:32768
    v_mfma_f32_16x16x32_bf16 v[88:91], v[232:235], v[200:203], v[88:91]
    buffer_load_dwordx4 v[164:167], v2, s[20:23], s73 offen offset:0 sc1
    v_mfma_f32_16x16x32_bf16 v[92:95], v[236:239], v[200:203], v[92:95]
    ds_read_b64_tr_b16 v[26:27], v249 offset:34816
    v_mfma_f32_16x16x32_bf16 v[96:99], v[240:243], v[200:203], v[96:99]
    buffer_load_dwordx4 v[168:171], v2, s[20:23], s73 offen offset:1024 sc1
    v_mfma_f32_16x16x32_bf16 v[100:103], v[228:231], v[204:207], v[100:103]
    ds_read_b64_tr_b16 v[28:29], v250 offset:32768
    v_mfma_f32_16x16x32_bf16 v[104:107], v[232:235], v[204:207], v[104:107]
    buffer_load_dwordx4 v[172:175], v2, s[20:23], s73 offen offset:2048 sc1
    v_mfma_f32_16x16x32_bf16 v[108:111], v[236:239], v[204:207], v[108:111]
    ds_read_b64_tr_b16 v[30:31], v250 offset:34816
    v_mfma_f32_16x16x32_bf16 v[112:115], v[240:243], v[204:207], v[112:115]
    buffer_load_dwordx4 v[176:179], v2, s[20:23], s73 offen offset:3072 sc1
    v_mfma_f32_16x16x32_bf16 v[116:119], v[228:231], v[208:211], v[116:119]
    ds_read_b64_tr_b16 v[32:33], v251 offset:32768
    v_mfma_f32_16x16x32_bf16 v[120:123], v[232:235], v[208:211], v[120:123]
    v_mfma_f32_16x16x32_bf16 v[124:127], v[236:239], v[208:211], v[124:127]
    ds_read_b64_tr_b16 v[34:35], v251 offset:34816
    v_mfma_f32_16x16x32_bf16 v[128:131], v[240:243], v[208:211], v[128:131]
    s_waitcnt vmcnt(12)
    s_waitcnt lgkmcnt(9)
    v_mfma_f32_16x16x32_bf16 v[68:71], v[4:7], v[212:215], v[68:71]
    ds_read_b64_tr_b16 v[36:37], v244 offset:0
    v_mfma_f32_16x16x32_bf16 v[72:75], v[8:11], v[212:215], v[72:75]
    s_mul_i32 s73, s37, 8192
    v_mfma_f32_16x16x32_bf16 v[76:79], v[12:15], v[212:215], v[76:79]
    ds_read_b64_tr_b16 v[38:39], v244 offset:2048
    v_mfma_f32_16x16x32_bf16 v[80:83], v[16:19], v[212:215], v[80:83]
    s_add_u32 s73, s73, s50
    v_mfma_f32_16x16x32_bf16 v[84:87], v[4:7], v[216:219], v[84:87]
    ds_read_b64_tr_b16 v[40:41], v245 offset:0
    v_mfma_f32_16x16x32_bf16 v[88:91], v[8:11], v[216:219], v[88:91]
    s_add_u32 s73, s73, 4096
    v_mfma_f32_16x16x32_bf16 v[92:95], v[12:15], v[216:219], v[92:95]
    ds_read_b64_tr_b16 v[42:43], v245 offset:2048
    v_mfma_f32_16x16x32_bf16 v[96:99], v[16:19], v[216:219], v[96:99]
    buffer_load_dwordx4 v[180:183], v2, s[20:23], s73 offen offset:0 sc1
    v_mfma_f32_16x16x32_bf16 v[100:103], v[4:7], v[220:223], v[100:103]
    ds_read_b64_tr_b16 v[44:45], v246 offset:0
    v_mfma_f32_16x16x32_bf16 v[104:107], v[8:11], v[220:223], v[104:107]
    buffer_load_dwordx4 v[184:187], v2, s[20:23], s73 offen offset:1024 sc1
    v_mfma_f32_16x16x32_bf16 v[108:111], v[12:15], v[220:223], v[108:111]
    ds_read_b64_tr_b16 v[46:47], v246 offset:2048
    v_mfma_f32_16x16x32_bf16 v[112:115], v[16:19], v[220:223], v[112:115]
    buffer_load_dwordx4 v[188:191], v2, s[20:23], s73 offen offset:2048 sc1
    v_mfma_f32_16x16x32_bf16 v[116:119], v[4:7], v[224:227], v[116:119]
    ds_read_b64_tr_b16 v[48:49], v247 offset:0
    v_mfma_f32_16x16x32_bf16 v[120:123], v[8:11], v[224:227], v[120:123]
    buffer_load_dwordx4 v[192:195], v2, s[20:23], s73 offen offset:3072 sc1
    v_mfma_f32_16x16x32_bf16 v[124:127], v[12:15], v[224:227], v[124:127]
    ds_read_b64_tr_b16 v[50:51], v247 offset:2048
    v_mfma_f32_16x16x32_bf16 v[128:131], v[16:19], v[224:227], v[128:131]
    s_waitcnt vmcnt(12)
    s_waitcnt lgkmcnt(8)
    v_mfma_f32_16x16x32_bf16 v[68:71], v[20:23], v[132:135], v[68:71]
    ds_read_b64_tr_b16 v[52:53], v244 offset:16384
    v_mfma_f32_16x16x32_bf16 v[72:75], v[24:27], v[132:135], v[72:75]
    s_mul_i32 s73, s38, 8192
    v_mfma_f32_16x16x32_bf16 v[76:79], v[28:31], v[132:135], v[76:79]
    ds_read_b64_tr_b16 v[54:55], v244 offset:18432
    v_mfma_f32_16x16x32_bf16 v[80:83], v[32:35], v[132:135], v[80:83]
    s_add_u32 s73, s73, s50
    v_mfma_f32_16x16x32_bf16 v[84:87], v[20:23], v[136:139], v[84:87]
    ds_read_b64_tr_b16 v[56:57], v245 offset:16384
    v_mfma_f32_16x16x32_bf16 v[88:91], v[24:27], v[136:139], v[88:91]
    buffer_load_dwordx4 v[228:231], v2, s[20:23], s73 offen offset:0 sc1
    v_mfma_f32_16x16x32_bf16 v[92:95], v[28:31], v[136:139], v[92:95]
    ds_read_b64_tr_b16 v[58:59], v245 offset:18432
    v_mfma_f32_16x16x32_bf16 v[96:99], v[32:35], v[136:139], v[96:99]
    buffer_load_dwordx4 v[232:235], v2, s[20:23], s73 offen offset:1024 sc1
    v_mfma_f32_16x16x32_bf16 v[100:103], v[20:23], v[140:143], v[100:103]
    ds_read_b64_tr_b16 v[60:61], v246 offset:16384
    v_mfma_f32_16x16x32_bf16 v[104:107], v[24:27], v[140:143], v[104:107]
    buffer_load_dwordx4 v[236:239], v2, s[20:23], s73 offen offset:2048 sc1
    v_mfma_f32_16x16x32_bf16 v[108:111], v[28:31], v[140:143], v[108:111]
    ds_read_b64_tr_b16 v[62:63], v246 offset:18432
    v_mfma_f32_16x16x32_bf16 v[112:115], v[32:35], v[140:143], v[112:115]
    buffer_load_dwordx4 v[240:243], v2, s[20:23], s73 offen offset:3072 sc1
    v_mfma_f32_16x16x32_bf16 v[116:119], v[20:23], v[144:147], v[116:119]
    ds_read_b64_tr_b16 v[64:65], v247 offset:16384
    v_mfma_f32_16x16x32_bf16 v[120:123], v[24:27], v[144:147], v[120:123]
    v_mfma_f32_16x16x32_bf16 v[124:127], v[28:31], v[144:147], v[124:127]
    ds_read_b64_tr_b16 v[66:67], v247 offset:18432
    v_mfma_f32_16x16x32_bf16 v[128:131], v[32:35], v[144:147], v[128:131]
    s_waitcnt vmcnt(12)
    s_waitcnt lgkmcnt(8)
    s_lshl_b32 s70, s59, 2
    v_mov_b32 v3, s70
    v_mfma_f32_16x16x32_bf16 v[68:71], v[36:39], v[148:151], v[68:71]
    ds_read_b64_tr_b16 v[196:197], v244 offset:32768
    v_mfma_f32_16x16x32_bf16 v[72:75], v[40:43], v[148:151], v[72:75]
    ds_read_b64_tr_b16 v[198:199], v244 offset:34816
    s_mul_i32 s73, s38, 8192
    v_mfma_f32_16x16x32_bf16 v[76:79], v[44:47], v[148:151], v[76:79]
    ds_read_b64_tr_b16 v[200:201], v245 offset:32768
    v_mfma_f32_16x16x32_bf16 v[80:83], v[48:51], v[148:151], v[80:83]
    s_add_u32 s73, s73, s50
    v_mfma_f32_16x16x32_bf16 v[84:87], v[36:39], v[152:155], v[84:87]
    ds_read_b64_tr_b16 v[202:203], v245 offset:34816
    v_mfma_f32_16x16x32_bf16 v[88:91], v[40:43], v[152:155], v[88:91]
    s_add_u32 s73, s73, 4096
    v_mfma_f32_16x16x32_bf16 v[92:95], v[44:47], v[152:155], v[92:95]
    ds_read_b64_tr_b16 v[204:205], v246 offset:32768
    v_mfma_f32_16x16x32_bf16 v[96:99], v[48:51], v[152:155], v[96:99]
    buffer_load_dwordx4 v[4:7], v2, s[20:23], s73 offen offset:0 sc1
    v_mfma_f32_16x16x32_bf16 v[100:103], v[36:39], v[156:159], v[100:103]
    ds_read_b64_tr_b16 v[206:207], v246 offset:34816
    v_mfma_f32_16x16x32_bf16 v[104:107], v[40:43], v[156:159], v[104:107]
    buffer_load_dwordx4 v[8:11], v2, s[20:23], s73 offen offset:1024 sc1
    v_mfma_f32_16x16x32_bf16 v[108:111], v[44:47], v[156:159], v[108:111]
    ds_read_b64_tr_b16 v[208:209], v247 offset:32768
    v_mfma_f32_16x16x32_bf16 v[112:115], v[48:51], v[156:159], v[112:115]
    buffer_load_dwordx4 v[12:15], v2, s[20:23], s73 offen offset:2048 sc1
    v_mfma_f32_16x16x32_bf16 v[116:119], v[36:39], v[160:163], v[116:119]
    ds_read_b64_tr_b16 v[210:211], v247 offset:34816
    v_mfma_f32_16x16x32_bf16 v[120:123], v[40:43], v[160:163], v[120:123]
    buffer_load_dwordx4 v[16:19], v2, s[20:23], s73 offen offset:3072 sc1
    v_mfma_f32_16x16x32_bf16 v[124:127], v[44:47], v[160:163], v[124:127]
    ds_read_b32 v255, v3 offset:32432
    v_mfma_f32_16x16x32_bf16 v[128:131], v[48:51], v[160:163], v[128:131]
    s_waitcnt vmcnt(12)
    s_waitcnt lgkmcnt(9)
    s_waitcnt lgkmcnt(0)
    v_cmp_ne_u32 vcc, s67, v255
    s_nop 4
    s_cbranch_vccz Lv_51
    s_lshl_b32 s70, s59, 2
    v_mov_b32 v212, s70
    s_mov_b32 s68, 2000000
Lab_52:
    ds_read_b32 v213, v212 offset:32432
    s_waitcnt lgkmcnt(0)
    v_cmp_ne_u32 vcc, s67, v213
    s_sub_u32 s68, s68, 1
    s_nop 3
    s_cbranch_vccz Lae_53
    s_cmp_lg_u32 s68, 0
    s_cbranch_scc1 Lab_52
Lae_53:
Lv_51:
    v_mfma_f32_16x16x32_bf16 v[68:71], v[52:55], v[164:167], v[68:71]
    ds_read_b64_tr_b16 v[212:213], v244 offset:49152
    v_mfma_f32_16x16x32_bf16 v[72:75], v[56:59], v[164:167], v[72:75]
    v_mfma_f32_16x16x32_bf16 v[76:79], v[60:63], v[164:167], v[76:79]
    ds_read_b64_tr_b16 v[214:215], v244 offset:51200
    v_mfma_f32_16x16x32_bf16 v[80:83], v[64:67], v[164:167], v[80:83]
    v_mfma_f32_16x16x32_bf16 v[84:87], v[52:55], v[168:171], v[84:87]
    ds_read_b64_tr_b16 v[216:217], v245 offset:49152
    v_mfma_f32_16x16x32_bf16 v[88:91], v[56:59], v[168:171], v[88:91]
    v_mfma_f32_16x16x32_bf16 v[92:95], v[60:63], v[168:171], v[92:95]
    ds_read_b64_tr_b16 v[218:219], v245 offset:51200
    v_mfma_f32_16x16x32_bf16 v[96:99], v[64:67], v[168:171], v[96:99]
    v_mfma_f32_16x16x32_bf16 v[100:103], v[52:55], v[172:175], v[100:103]
    ds_read_b64_tr_b16 v[220:221], v246 offset:49152
    v_mfma_f32_16x16x32_bf16 v[104:107], v[56:59], v[172:175], v[104:107]
    v_mfma_f32_16x16x32_bf16 v[108:111], v[60:63], v[172:175], v[108:111]
    ds_read_b64_tr_b16 v[222:223], v246 offset:51200
    v_mfma_f32_16x16x32_bf16 v[112:115], v[64:67], v[172:175], v[112:115]
    v_mfma_f32_16x16x32_bf16 v[116:119], v[52:55], v[176:179], v[116:119]
    ds_read_b64_tr_b16 v[224:225], v247 offset:49152
    v_mfma_f32_16x16x32_bf16 v[120:123], v[56:59], v[176:179], v[120:123]
    v_mfma_f32_16x16x32_bf16 v[124:127], v[60:63], v[176:179], v[124:127]
    ds_read_b64_tr_b16 v[226:227], v247 offset:51200
    v_mfma_f32_16x16x32_bf16 v[128:131], v[64:67], v[176:179], v[128:131]
    s_waitcnt vmcnt(8)
    v_mfma_f32_16x16x32_bf16 v[68:71], v[196:199], v[180:183], v[68:71]
    ds_read_b64_tr_b16 v[20:21], v248 offset:0
    v_mfma_f32_16x16x32_bf16 v[72:75], v[200:203], v[180:183], v[72:75]
    v_mfma_f32_16x16x32_bf16 v[76:79], v[204:207], v[180:183], v[76:79]
    ds_read_b64_tr_b16 v[22:23], v248 offset:2048
    v_mfma_f32_16x16x32_bf16 v[80:83], v[208:211], v[180:183], v[80:83]
    v_mfma_f32_16x16x32_bf16 v[84:87], v[196:199], v[184:187], v[84:87]
    ds_read_b64_tr_b16 v[24:25], v249 offset:0
    v_mfma_f32_16x16x32_bf16 v[88:91], v[200:203], v[184:187], v[88:91]
    v_mfma_f32_16x16x32_bf16 v[92:95], v[204:207], v[184:187], v[92:95]
    ds_read_b64_tr_b16 v[26:27], v249 offset:2048
    v_mfma_f32_16x16x32_bf16 v[96:99], v[208:211], v[184:187], v[96:99]
    v_mfma_f32_16x16x32_bf16 v[100:103], v[196:199], v[188:191], v[100:103]
    ds_read_b64_tr_b16 v[28:29], v250 offset:0
    v_mfma_f32_16x16x32_bf16 v[104:107], v[200:203], v[188:191], v[104:107]
    v_mfma_f32_16x16x32_bf16 v[108:111], v[204:207], v[188:191], v[108:111]
    ds_read_b64_tr_b16 v[30:31], v250 offset:2048
    v_mfma_f32_16x16x32_bf16 v[112:115], v[208:211], v[188:191], v[112:115]
    v_mfma_f32_16x16x32_bf16 v[116:119], v[196:199], v[192:195], v[116:119]
    ds_read_b64_tr_b16 v[32:33], v251 offset:0
    v_mfma_f32_16x16x32_bf16 v[120:123], v[200:203], v[192:195], v[120:123]
    v_mfma_f32_16x16x32_bf16 v[124:127], v[204:207], v[192:195], v[124:127]
    ds_read_b64_tr_b16 v[34:35], v251 offset:2048
    v_mfma_f32_16x16x32_bf16 v[128:131], v[208:211], v[192:195], v[128:131]
    s_waitcnt vmcnt(4)
    s_waitcnt lgkmcnt(8)
    v_and_b32 v252, 7, v1
    v_lshrrev_b32 v253, 5, v1
    v_xor_b32 v253, v253, v252
    v_lshlrev_b32 v253, 4, v253
    v_and_b32 v252, 15, v1
    v_lshl_add_u32 v252, v252, 7, s52
    v_add_u32 v252, v252, v253
    v_bfe_u32 v253, v1, 4, 1
    v_lshl_add_u32 v252, v253, 3, v252
    v_xor_b32 v253, 32, v252
    v_xor_b32 v254, 64, v252
    v_xor_b32 v255, 96, v252
    v_mfma_f32_16x16x32_bf16 v[68:71], v[212:215], v[228:231], v[68:71]
    v_mfma_f32_16x16x32_bf16 v[72:75], v[216:219], v[228:231], v[72:75]
    v_mfma_f32_16x16x32_bf16 v[76:79], v[220:223], v[228:231], v[76:79]
    v_mfma_f32_16x16x32_bf16 v[80:83], v[224:227], v[228:231], v[80:83]
    v_mfma_f32_16x16x32_bf16 v[84:87], v[212:215], v[232:235], v[84:87]
    v_mfma_f32_16x16x32_bf16 v[88:91], v[216:219], v[232:235], v[88:91]
    v_mfma_f32_16x16x32_bf16 v[92:95], v[220:223], v[232:235], v[92:95]
    v_mfma_f32_16x16x32_bf16 v[96:99], v[224:227], v[232:235], v[96:99]
    v_mfma_f32_16x16x32_bf16 v[100:103], v[212:215], v[236:239], v[100:103]
    v_mfma_f32_16x16x32_bf16 v[104:107], v[216:219], v[236:239], v[104:107]
    v_mfma_f32_16x16x32_bf16 v[108:111], v[220:223], v[236:239], v[108:111]
    v_mfma_f32_16x16x32_bf16 v[112:115], v[224:227], v[236:239], v[112:115]
    v_mfma_f32_16x16x32_bf16 v[116:119], v[212:215], v[240:243], v[116:119]
    v_mfma_f32_16x16x32_bf16 v[120:123], v[216:219], v[240:243], v[120:123]
    v_mfma_f32_16x16x32_bf16 v[124:127], v[220:223], v[240:243], v[124:127]
    v_mfma_f32_16x16x32_bf16 v[128:131], v[224:227], v[240:243], v[128:131]
    s_waitcnt vmcnt(0)
    s_waitcnt lgkmcnt(0)
    v_mfma_f32_16x16x32_bf16 v[68:71], v[20:23], v[4:7], v[68:71]
    v_mfma_f32_16x16x32_bf16 v[72:75], v[24:27], v[4:7], v[72:75]
    v_mfma_f32_16x16x32_bf16 v[76:79], v[28:31], v[4:7], v[76:79]
    v_mfma_f32_16x16x32_bf16 v[80:83], v[32:35], v[4:7], v[80:83]
    v_mfma_f32_16x16x32_bf16 v[84:87], v[20:23], v[8:11], v[84:87]
    s_nop 3
    v_cvt_pk_bf16_f32 v68, v68, v69
    v_cvt_pk_bf16_f32 v69, v70, v71
    ds_write_b64 v252, v[68:69] offset:0
    v_mfma_f32_16x16x32_bf16 v[88:91], v[24:27], v[8:11], v[88:91]
    v_cvt_pk_bf16_f32 v72, v72, v73
    v_cvt_pk_bf16_f32 v73, v74, v75
    ds_write_b64 v253, v[72:73] offset:0
    v_mfma_f32_16x16x32_bf16 v[92:95], v[28:31], v[8:11], v[92:95]
    v_cvt_pk_bf16_f32 v76, v76, v77
    v_cvt_pk_bf16_f32 v77, v78, v79
    ds_write_b64 v254, v[76:77] offset:0
    v_mfma_f32_16x16x32_bf16 v[96:99], v[32:35], v[8:11], v[96:99]
    v_cvt_pk_bf16_f32 v80, v80, v81
    v_cvt_pk_bf16_f32 v81, v82, v83
    ds_write_b64 v255, v[80:81] offset:0
    v_mfma_f32_16x16x32_bf16 v[100:103], v[20:23], v[12:15], v[100:103]
    v_cvt_pk_bf16_f32 v84, v84, v85
    v_cvt_pk_bf16_f32 v85, v86, v87
    ds_write_b64 v252, v[84:85] offset:16384
    v_mfma_f32_16x16x32_bf16 v[104:107], v[24:27], v[12:15], v[104:107]
    v_cvt_pk_bf16_f32 v88, v88, v89
    v_cvt_pk_bf16_f32 v89, v90, v91
    ds_write_b64 v253, v[88:89] offset:16384
    v_mfma_f32_16x16x32_bf16 v[108:111], v[28:31], v[12:15], v[108:111]
    v_cvt_pk_bf16_f32 v92, v92, v93
    v_cvt_pk_bf16_f32 v93, v94, v95
    ds_write_b64 v254, v[92:93] offset:16384
    v_mfma_f32_16x16x32_bf16 v[112:115], v[32:35], v[12:15], v[112:115]
    v_cvt_pk_bf16_f32 v96, v96, v97
    v_cvt_pk_bf16_f32 v97, v98, v99
    ds_write_b64 v255, v[96:97] offset:16384
    v_mfma_f32_16x16x32_bf16 v[116:119], v[20:23], v[16:19], v[116:119]
    v_cvt_pk_bf16_f32 v100, v100, v101
    v_cvt_pk_bf16_f32 v101, v102, v103
    ds_write_b64 v252, v[100:101] offset:32768
    v_mfma_f32_16x16x32_bf16 v[120:123], v[24:27], v[16:19], v[120:123]
    v_cvt_pk_bf16_f32 v104, v104, v105
    v_cvt_pk_bf16_f32 v105, v106, v107
    ds_write_b64 v253, v[104:105] offset:32768
    v_mfma_f32_16x16x32_bf16 v[124:127], v[28:31], v[16:19], v[124:127]
    v_cvt_pk_bf16_f32 v108, v108, v109
    v_cvt_pk_bf16_f32 v109, v110, v111
    ds_write_b64 v254, v[108:109] offset:32768
    v_mfma_f32_16x16x32_bf16 v[128:131], v[32:35], v[16:19], v[128:131]
    v_cvt_pk_bf16_f32 v112, v112, v113
    v_cvt_pk_bf16_f32 v113, v114, v115
    ds_write_b64 v255, v[112:113] offset:32768
    v_cvt_pk_bf16_f32 v116, v116, v117
    v_cvt_pk_bf16_f32 v117, v118, v119
    ds_write_b64 v252, v[116:117] offset:49152
    v_cvt_pk_bf16_f32 v120, v120, v121
    v_cvt_pk_bf16_f32 v121, v122, v123
    ds_write_b64 v253, v[120:121] offset:49152
    v_cvt_pk_bf16_f32 v124, v124, v125
    v_cvt_pk_bf16_f32 v125, v126, v127
    ds_write_b64 v254, v[124:125] offset:49152
    v_cvt_pk_bf16_f32 v128, v128, v129
    v_cvt_pk_bf16_f32 v129, v130, v131
    ds_write_b64 v255, v[128:129] offset:49152
    s_waitcnt lgkmcnt(0)
    s_barrier
    s_endpgm
L_helper:
    s_mov_b64 s[18:19], s[10:11]
    s_mov_b64 s[26:27], s[6:7]
    s_mov_b32 s22, 0x10000000
    s_mov_b32 s23, s7
    s_movk_i32 s30, 256
    s_mov_b32 s31, s7
    v_lshrrev_b32 v160, 3, v0
    v_and_b32 v161, 7, v0
    v_lshlrev_b32 v96, 4, v161
    v_lshrrev_b32 v162, 4, v0
    v_mul_u32_u24 v162, 3584, v162
    v_and_b32 v97, 15, v1
    v_lshl_add_u32 v162, v97, 4, v162
    v_mul_u32_u24 v163, 896, v160
    v_add_u32 v163, v163, v96
    s_lshl2_add_u32 s61, s70, s71
    s_and_b32 s72, s70, 1
    s_lshl2_add_u32 s72, s72, s71
    s_bfe_u32 s73, s70, 0x10001
    s_mul_i32 s73, s73, 7
    s_add_u32 s71, s72, s73
    s_lshl_b32 s71, s71, 8
    s_lshr_b32 s65, s70, 2
    s_lshl_b32 s65, s65, 3
    s_lshl3_add_u32 s62, s71, s65
    s_cmp_eq_u32 s72, 7
    s_cselect_b32 s10, 0, s10
    s_cselect_b32 s62, 0x8000, s62
    s_mul_i32 s72, s61, 57344
    s_waitcnt lgkmcnt(0)
    s_or_b32 s73, s2, s60
    s_cmp_lg_u32 s73, 0
    s_cbranch_scc1 Lnn_54
    s_or_b32 s70, s44, 1
    v_mov_b32 v2, s70
    s_mov_b64 exec, 1
    buffer_store_dword v2, off, s[28:31], 0 sc1
    s_mov_b64 exec, -1
Lnn_54:
    s_cmp_ge_u32 s65, 7
    s_cselect_b32 s8, s12, s8
    s_cselect_b32 s9, s13, s9
    buffer_load_dwordx4 v[32:35], v163, s[4:7], s72 offen offset:0
    buffer_load_dwordx4 v[36:39], v163, s[4:7], s72 offen offset:128
    buffer_load_dwordx4 v[40:43], v163, s[4:7], s72 offen offset:256
    buffer_load_dwordx4 v[44:47], v163, s[4:7], s72 offen offset:384
    buffer_load_dwordx4 v[48:51], v163, s[4:7], s72 offen offset:512
    buffer_load_dwordx4 v[52:55], v163, s[4:7], s72 offen offset:640
    buffer_load_dwordx4 v[56:59], v163, s[4:7], s72 offen offset:768
    s_mov_b32 s48, 0x3f80
    s_mov_b32 s49, 0x3f800000
    s_mov_b32 s50, 0x3f803f80
    v_lshrrev_b32 v96, 4, v1
    v_lshlrev_b32 v96, 3, v96
    v_lshl_add_u32 v96, v97, 5, v96
    s_lshl_b32 s73, s60, 9
    v_add_u32 v164, s73, v96
    v_mov_b32 v88, 0
    v_mov_b32 v89, 0
    v_mov_b32 v90, 0
    v_mov_b32 v91, 0
    v_lshlrev_b32 v98, 3, v160
    s_lshl_b32 s74, s61, 9
    s_waitcnt vmcnt(0)
    v_dot2c_f32_bf16 v88, s50, v32
    v_dot2c_f32_bf16 v89, s50, v33
    v_dot2c_f32_bf16 v90, s50, v34
    v_dot2c_f32_bf16 v91, s50, v35
    v_dot2c_f32_bf16 v88, s50, v36
    v_dot2c_f32_bf16 v89, s50, v37
    v_dot2c_f32_bf16 v90, s50, v38
    v_dot2c_f32_bf16 v91, s50, v39
    v_dot2c_f32_bf16 v88, s50, v40
    v_dot2c_f32_bf16 v89, s50, v41
    v_dot2c_f32_bf16 v90, s50, v42
    v_dot2c_f32_bf16 v91, s50, v43
    v_dot2c_f32_bf16 v88, s50, v44
    v_dot2c_f32_bf16 v89, s50, v45
    v_dot2c_f32_bf16 v90, s50, v46
    v_dot2c_f32_bf16 v91, s50, v47
    v_dot2c_f32_bf16 v88, s50, v48
    v_dot2c_f32_bf16 v89, s50, v49
    v_dot2c_f32_bf16 v90, s50, v50
    v_dot2c_f32_bf16 v91, s50, v51
    v_dot2c_f32_bf16 v88, s50, v52
    v_dot2c_f32_bf16 v89, s50, v53
    v_dot2c_f32_bf16 v90, s50, v54
    v_dot2c_f32_bf16 v91, s50, v55
    v_dot2c_f32_bf16 v88, s50, v56
    v_dot2c_f32_bf16 v89, s50, v57
    v_dot2c_f32_bf16 v90, s50, v58
    v_dot2c_f32_bf16 v91, s50, v59
    s_nop 0
    v_add_f32 v88, v88, v89
    s_nop 0
    v_add_f32 v90, v90, v91
    v_add_f32 v165, v88, v90
    s_nop 1
    v_add_f32_dpp v165, v165, v165 quad_perm:[1,0,3,2] row_mask:0xf bank_mask:0xf
    s_nop 1
    v_add_f32_dpp v165, v165, v165 quad_perm:[2,3,0,1] row_mask:0xf bank_mask:0xf
    s_nop 1
    v_add_f32_dpp v165, v165, v165 row_half_mirror row_mask:0xf bank_mask:0xf
    v_mul_f32 v166, 0xbb124925, v165
    v_cvt_pk_bf16_f32 v172, 0, v166
    buffer_load_dword v168, off, s[28:31], 0 sc1
    v_dot2_f32_bf16 v100, v32, s48, v172
    v_dot2_f32_bf16 v101, v32, s49, v172
    v_dot2_f32_bf16 v102, v33, s48, v172
    v_dot2_f32_bf16 v103, v33, s49, v172
    v_dot2_f32_bf16 v104, v34, s48, v172
    v_dot2_f32_bf16 v105, v34, s49, v172
    v_dot2_f32_bf16 v106, v35, s48, v172
    v_dot2_f32_bf16 v107, v35, s49, v172
    v_dot2_f32_bf16 v108, v36, s48, v172
    v_dot2_f32_bf16 v109, v36, s49, v172
    v_dot2_f32_bf16 v110, v37, s48, v172
    v_dot2_f32_bf16 v111, v37, s49, v172
    v_dot2_f32_bf16 v112, v38, s48, v172
    v_dot2_f32_bf16 v113, v38, s49, v172
    s_add_u32 s73, s71, 688128
    buffer_load_dwordx4 v[28:31], v162, s[8:11], s73 offen
    v_dot2_f32_bf16 v114, v39, s48, v172
    v_dot2_f32_bf16 v115, v39, s49, v172
    v_dot2_f32_bf16 v116, v40, s48, v172
    v_dot2_f32_bf16 v117, v40, s49, v172
    v_dot2_f32_bf16 v118, v41, s48, v172
    v_dot2_f32_bf16 v119, v41, s49, v172
    v_dot2_f32_bf16 v120, v42, s48, v172
    v_dot2_f32_bf16 v121, v42, s49, v172
    v_dot2_f32_bf16 v122, v43, s48, v172
    v_dot2_f32_bf16 v123, v43, s49, v172
    v_dot2_f32_bf16 v124, v44, s48, v172
    v_dot2_f32_bf16 v125, v44, s49, v172
    v_dot2_f32_bf16 v126, v45, s48, v172
    v_dot2_f32_bf16 v127, v45, s49, v172
    s_add_u32 s73, s71, 802816
    buffer_load_dwordx4 v[60:63], v162, s[8:11], s73 offen
    v_dot2_f32_bf16 v128, v46, s48, v172
    v_dot2_f32_bf16 v129, v46, s49, v172
    v_dot2_f32_bf16 v130, v47, s48, v172
    v_dot2_f32_bf16 v131, v47, s49, v172
    v_dot2_f32_bf16 v132, v48, s48, v172
    v_dot2_f32_bf16 v133, v48, s49, v172
    v_dot2_f32_bf16 v134, v49, s48, v172
    v_dot2_f32_bf16 v135, v49, s49, v172
    v_dot2_f32_bf16 v136, v50, s48, v172
    v_dot2_f32_bf16 v137, v50, s49, v172
    v_dot2_f32_bf16 v138, v51, s48, v172
    v_dot2_f32_bf16 v139, v51, s49, v172
    v_dot2_f32_bf16 v140, v52, s48, v172
    v_dot2_f32_bf16 v141, v52, s49, v172
    s_add_u32 s73, s71, 917504
    buffer_load_dwordx4 v[64:67], v162, s[8:11], s73 offen
    v_dot2_f32_bf16 v142, v53, s48, v172
    v_dot2_f32_bf16 v143, v53, s49, v172
    v_dot2_f32_bf16 v144, v54, s48, v172
    v_dot2_f32_bf16 v145, v54, s49, v172
    v_dot2_f32_bf16 v146, v55, s48, v172
    v_dot2_f32_bf16 v147, v55, s49, v172
    v_dot2_f32_bf16 v148, v56, s48, v172
    v_dot2_f32_bf16 v149, v56, s49, v172
    v_dot2_f32_bf16 v150, v57, s48, v172
    v_dot2_f32_bf16 v151, v57, s49, v172
    v_dot2_f32_bf16 v152, v58, s48, v172
    v_dot2_f32_bf16 v153, v58, s49, v172
    v_dot2_f32_bf16 v154, v59, s48, v172
    v_dot2_f32_bf16 v155, v59, s49, v172
    s_add_u32 s73, s71, 1032192
    buffer_load_dwordx4 v[68:71], v162, s[8:11], s73 offen
    v_pk_mul_f32 v[88:89], v[100:101], v[100:101]
    v_pk_mul_f32 v[90:91], v[102:103], v[102:103]
    v_pk_fma_f32 v[88:89], v[104:105], v[104:105], v[88:89]
    v_pk_fma_f32 v[90:91], v[106:107], v[106:107], v[90:91]
    v_pk_fma_f32 v[88:89], v[108:109], v[108:109], v[88:89]
    v_pk_fma_f32 v[90:91], v[110:111], v[110:111], v[90:91]
    v_pk_fma_f32 v[88:89], v[112:113], v[112:113], v[88:89]
    v_pk_fma_f32 v[90:91], v[114:115], v[114:115], v[90:91]
    v_pk_fma_f32 v[88:89], v[116:117], v[116:117], v[88:89]
    v_pk_fma_f32 v[90:91], v[118:119], v[118:119], v[90:91]
    v_pk_fma_f32 v[88:89], v[120:121], v[120:121], v[88:89]
    v_pk_fma_f32 v[90:91], v[122:123], v[122:123], v[90:91]
    v_pk_fma_f32 v[88:89], v[124:125], v[124:125], v[88:89]
    s_add_u32 s73, s71, 1146880
    buffer_load_dwordx4 v[72:75], v162, s[8:11], s73 offen
    v_pk_fma_f32 v[90:91], v[126:127], v[126:127], v[90:91]
    v_pk_fma_f32 v[88:89], v[128:129], v[128:129], v[88:89]
    v_pk_fma_f32 v[90:91], v[130:131], v[130:131], v[90:91]
    v_pk_fma_f32 v[88:89], v[132:133], v[132:133], v[88:89]
    v_pk_fma_f32 v[90:91], v[134:135], v[134:135], v[90:91]
    v_pk_fma_f32 v[88:89], v[136:137], v[136:137], v[88:89]
    v_pk_fma_f32 v[90:91], v[138:139], v[138:139], v[90:91]
    v_pk_fma_f32 v[88:89], v[140:141], v[140:141], v[88:89]
    v_pk_fma_f32 v[90:91], v[142:143], v[142:143], v[90:91]
    v_pk_fma_f32 v[88:89], v[144:145], v[144:145], v[88:89]
    v_pk_fma_f32 v[90:91], v[146:147], v[146:147], v[90:91]
    v_pk_fma_f32 v[88:89], v[148:149], v[148:149], v[88:89]
    v_pk_fma_f32 v[90:91], v[150:151], v[150:151], v[90:91]
    s_add_u32 s73, s71, 1261568
    buffer_load_dwordx4 v[76:79], v162, s[8:11], s73 offen
    v_pk_fma_f32 v[88:89], v[152:153], v[152:153], v[88:89]
    v_pk_fma_f32 v[90:91], v[154:155], v[154:155], v[90:91]
    v_add_f32 v88, v88, v89
    v_add_f32 v90, v90, v91
    v_add_f32 v165, v88, v90
    v_sub_f32 v166, v166, v172
    v_cvt_pk_bf16_f32 v100, 0, v100
    v_cvt_pk_bf16_f32 v101, 0, v101
    v_add_f32_dpp v165, v165, v165 quad_perm:[1,0,3,2] row_mask:0xf bank_mask:0xf
    v_cvt_pk_bf16_f32 v102, 0, v102
    v_cvt_pk_bf16_f32 v103, 0, v103
    v_add_f32_dpp v165, v165, v165 quad_perm:[2,3,0,1] row_mask:0xf bank_mask:0xf
    v_cvt_pk_bf16_f32 v104, 0, v104
    v_cvt_pk_bf16_f32 v105, 0, v105
    v_add_f32_dpp v165, v165, v165 row_half_mirror row_mask:0xf bank_mask:0xf
    v_cvt_pk_bf16_f32 v106, 0, v106
    v_cvt_pk_bf16_f32 v107, 0, v107
    v_mul_f32 v166, v166, v166
    v_cvt_pk_bf16_f32 v108, 0, v108
    v_cvt_pk_bf16_f32 v109, 0, v109
    v_mul_f32 v165, 0x3b124925, v165
    s_add_u32 s73, s71, 1376256
    buffer_load_dwordx4 v[80:83], v162, s[8:11], s73 offen
    v_cvt_pk_bf16_f32 v110, 0, v110
    v_cvt_pk_bf16_f32 v111, 0, v111
    v_sub_f32 v165, v165, v166
    v_cvt_pk_bf16_f32 v112, 0, v112
    v_cvt_pk_bf16_f32 v113, 0, v113
    v_max_f32 v165, 0, v165
    v_cvt_pk_bf16_f32 v114, 0, v114
    v_cvt_pk_bf16_f32 v115, 0, v115
    v_cvt_pk_bf16_f32 v165, 0, v165
    v_cvt_pk_bf16_f32 v116, 0, v116
    v_cvt_pk_bf16_f32 v117, 0, v117
    v_add_f32 v165, 0x3727c5ac, v165
    v_cvt_pk_bf16_f32 v118, 0, v118
    v_cvt_pk_bf16_f32 v119, 0, v119
    v_cvt_pk_bf16_f32 v165, 0, v165
    s_add_u32 s73, s71, 1490944
    buffer_load_dwordx4 v[84:87], v162, s[8:11], s73 offen
    v_cvt_pk_bf16_f32 v120, 0, v120
    v_cvt_pk_bf16_f32 v121, 0, v121
    v_sqrt_f32 v165, v165
    v_cvt_pk_bf16_f32 v122, 0, v122
    v_cvt_pk_bf16_f32 v123, 0, v123
    v_cvt_pk_bf16_f32 v165, 0, v165
    v_cvt_pk_bf16_f32 v124, 0, v124
    v_cvt_pk_bf16_f32 v125, 0, v125
    v_rcp_f32 v170, v165
    v_cvt_pk_bf16_f32 v126, 0, v126
    v_cvt_pk_bf16_f32 v127, 0, v127
    v_mul_f32 v94, v170, v170
    v_cvt_pk_bf16_f32 v128, 0, v128
    v_cvt_pk_bf16_f32 v129, 0, v129
    v_mov_b32 v171, v170
    s_movk_i32 s77, 600
    s_waitcnt vmcnt(8)
    v_readfirstlane_b32 s67, v168
    s_nop 0
    s_sub_u32 s76, s44, s67
    s_cmp_lt_i32 s76, s77
    s_cselect_b32 s76, s67, 0
    s_cmp_lg_u32 s76, 0
    s_cbranch_scc1 Lnok_56
    s_mov_b32 s68, 200000
Lnon_55:
    buffer_load_dword v168, off, s[28:31], 0 sc1
    s_waitcnt vmcnt(0)
    v_readfirstlane_b32 s67, v168
    s_nop 0
    s_sub_u32 s76, s44, s67
    s_cmp_lt_i32 s76, s77
    s_cselect_b32 s76, s67, 0
    s_cmp_lg_u32 s76, 0
    s_cbranch_scc1 Lnok_56
    s_sub_u32 s68, s68, 1
    s_cmp_lt_u32 s68, 199900
    s_cselect_b32 s77, 0x7fffffff, s77
    s_cmp_lg_u32 s68, 0
    s_cbranch_scc1 Lnon_55
Lnok_56:
    v_mov_b32 v95, s67
    v_mov_b32 v173, s67
    s_add_u32 s70, s74, 14811136
    s_add_u32 s73, s74, 14745600
    s_mov_b32 exec_lo, 0x01010101
    s_mov_b32 exec_hi, 0x01010101
    buffer_store_dwordx2 v[172:173], v98, s[20:23], s73 offen sc1
    buffer_store_dwordx2 v[94:95], v98, s[20:23], s70 offen sc1
    s_mov_b64 exec, -1
    v_cvt_pk_bf16_f32 v130, 0, v130
    v_cvt_pk_bf16_f32 v131, 0, v131
    v_cvt_pk_bf16_f32 v132, 0, v132
    v_cvt_pk_bf16_f32 v133, 0, v133
    v_cvt_pk_bf16_f32 v134, 0, v134
    v_cvt_pk_bf16_f32 v135, 0, v135
    v_cvt_pk_bf16_f32 v136, 0, v136
    v_cvt_pk_bf16_f32 v137, 0, v137
    v_cvt_pk_bf16_f32 v138, 0, v138
    v_cvt_pk_bf16_f32 v139, 0, v139
    v_cvt_pk_bf16_f32 v140, 0, v140
    v_cvt_pk_bf16_f32 v141, 0, v141
    v_cvt_pk_bf16_f32 v142, 0, v142
    v_cvt_pk_bf16_f32 v143, 0, v143
    v_cvt_pk_bf16_f32 v144, 0, v144
    v_cvt_pk_bf16_f32 v145, 0, v145
    v_cvt_pk_bf16_f32 v146, 0, v146
    v_cvt_pk_bf16_f32 v147, 0, v147
    v_cvt_pk_bf16_f32 v148, 0, v148
    v_cvt_pk_bf16_f32 v149, 0, v149
    v_cvt_pk_bf16_f32 v150, 0, v150
    v_cvt_pk_bf16_f32 v151, 0, v151
    v_cvt_pk_bf16_f32 v152, 0, v152
    v_cvt_pk_bf16_f32 v153, 0, v153
    v_cvt_pk_bf16_f32 v154, 0, v154
    v_cvt_pk_bf16_f32 v155, 0, v155
    v_mul_u32_u24 v96, 912, v160
    v_lshl_add_u32 v96, v161, 4, v96
    v_pk_mul_f32 v[100:101], v[100:101], v[170:171]
    v_pk_mul_f32 v[102:103], v[102:103], v[170:171]
    v_pk_mul_f32 v[104:105], v[104:105], v[170:171]
    v_pk_mul_f32 v[106:107], v[106:107], v[170:171]
    v_cvt_pk_bf16_f32 v32, v100, v101
    v_cvt_pk_bf16_f32 v33, v102, v103
    v_cvt_pk_bf16_f32 v34, v104, v105
    v_cvt_pk_bf16_f32 v35, v106, v107
    ds_write_b128 v96, v[32:35] offset:0
    v_pk_mul_f32 v[108:109], v[108:109], v[170:171]
    v_pk_mul_f32 v[110:111], v[110:111], v[170:171]
    v_pk_mul_f32 v[112:113], v[112:113], v[170:171]
    v_pk_mul_f32 v[114:115], v[114:115], v[170:171]
    v_cvt_pk_bf16_f32 v36, v108, v109
    v_cvt_pk_bf16_f32 v37, v110, v111
    v_cvt_pk_bf16_f32 v38, v112, v113
    v_cvt_pk_bf16_f32 v39, v114, v115
    ds_write_b128 v96, v[36:39] offset:128
    v_pk_mul_f32 v[116:117], v[116:117], v[170:171]
    v_pk_mul_f32 v[118:119], v[118:119], v[170:171]
    v_pk_mul_f32 v[120:121], v[120:121], v[170:171]
    v_pk_mul_f32 v[122:123], v[122:123], v[170:171]
    v_cvt_pk_bf16_f32 v40, v116, v117
    v_cvt_pk_bf16_f32 v41, v118, v119
    v_cvt_pk_bf16_f32 v42, v120, v121
    v_cvt_pk_bf16_f32 v43, v122, v123
    ds_write_b128 v96, v[40:43] offset:256
    v_pk_mul_f32 v[124:125], v[124:125], v[170:171]
    v_pk_mul_f32 v[126:127], v[126:127], v[170:171]
    v_pk_mul_f32 v[128:129], v[128:129], v[170:171]
    v_pk_mul_f32 v[130:131], v[130:131], v[170:171]
    v_cvt_pk_bf16_f32 v44, v124, v125
    v_cvt_pk_bf16_f32 v45, v126, v127
    v_cvt_pk_bf16_f32 v46, v128, v129
    v_cvt_pk_bf16_f32 v47, v130, v131
    ds_write_b128 v96, v[44:47] offset:384
    v_pk_mul_f32 v[132:133], v[132:133], v[170:171]
    v_pk_mul_f32 v[134:135], v[134:135], v[170:171]
    v_pk_mul_f32 v[136:137], v[136:137], v[170:171]
    v_pk_mul_f32 v[138:139], v[138:139], v[170:171]
    v_cvt_pk_bf16_f32 v48, v132, v133
    v_cvt_pk_bf16_f32 v49, v134, v135
    v_cvt_pk_bf16_f32 v50, v136, v137
    v_cvt_pk_bf16_f32 v51, v138, v139
    ds_write_b128 v96, v[48:51] offset:512
    v_pk_mul_f32 v[140:141], v[140:141], v[170:171]
    v_pk_mul_f32 v[142:143], v[142:143], v[170:171]
    v_pk_mul_f32 v[144:145], v[144:145], v[170:171]
    v_pk_mul_f32 v[146:147], v[146:147], v[170:171]
    v_cvt_pk_bf16_f32 v52, v140, v141
    v_cvt_pk_bf16_f32 v53, v142, v143
    v_cvt_pk_bf16_f32 v54, v144, v145
    v_cvt_pk_bf16_f32 v55, v146, v147
    ds_write_b128 v96, v[52:55] offset:640
    v_pk_mul_f32 v[148:149], v[148:149], v[170:171]
    v_pk_mul_f32 v[150:151], v[150:151], v[170:171]
    v_pk_mul_f32 v[152:153], v[152:153], v[170:171]
    v_pk_mul_f32 v[154:155], v[154:155], v[170:171]
    v_cvt_pk_bf16_f32 v56, v148, v149
    v_cvt_pk_bf16_f32 v57, v150, v151
    v_cvt_pk_bf16_f32 v58, v152, v153
    v_cvt_pk_bf16_f32 v59, v154, v155
    ds_write_b128 v96, v[56:59] offset:768
    v_bfe_u32 v97, v1, 4, 1
    v_and_b32 v99, 3, v1
    v_lshl_add_u32 v97, v97, 2, v99
    v_bfe_u32 v99, v1, 2, 2
    v_lshl_add_u32 v97, v97, 3, v99
    v_mul_u32_u24 v97, 912, v97
    v_lshrrev_b32 v99, 5, v1
    v_lshl_add_u32 v97, v99, 3, v97
    s_lshl_b32 s73, s60, 4
    v_add_u32 v97, s73, v97
    v_lshlrev_b32 v98, 4, v1
    s_mul_i32 s72, s61, 57344
    s_lshl_b32 s70, s60, 10
    s_add_u32 s72, s72, s70
    s_add_u32 s72, s72, 8388608
    s_waitcnt lgkmcnt(0)
    s_barrier
    ds_read_b64_tr_b16 v[32:33], v97 offset:0
    ds_read_b64_tr_b16 v[34:35], v97 offset:3648
    ds_read_b64_tr_b16 v[36:37], v97 offset:128
    ds_read_b64_tr_b16 v[38:39], v97 offset:3776
    ds_read_b64_tr_b16 v[40:41], v97 offset:256
    ds_read_b64_tr_b16 v[42:43], v97 offset:3904
    ds_read_b64_tr_b16 v[44:45], v97 offset:384
    ds_read_b64_tr_b16 v[46:47], v97 offset:4032
    ds_read_b64_tr_b16 v[48:49], v97 offset:512
    ds_read_b64_tr_b16 v[50:51], v97 offset:4160
    ds_read_b64_tr_b16 v[52:53], v97 offset:640
    ds_read_b64_tr_b16 v[54:55], v97 offset:4288
    ds_read_b64_tr_b16 v[56:57], v97 offset:768
    ds_read_b64_tr_b16 v[58:59], v97 offset:4416
    s_waitcnt lgkmcnt(12)
    buffer_store_dwordx4 v[32:35], v98, s[20:23], s72 offen sc1
    s_add_u32 s72, s72, 8192
    s_waitcnt lgkmcnt(10)
    buffer_store_dwordx4 v[36:39], v98, s[20:23], s72 offen sc1
    s_add_u32 s72, s72, 8192
    s_waitcnt lgkmcnt(8)
    buffer_store_dwordx4 v[40:43], v98, s[20:23], s72 offen sc1
    s_add_u32 s72, s72, 8192
    s_waitcnt lgkmcnt(6)
    buffer_store_dwordx4 v[44:47], v98, s[20:23], s72 offen sc1
    s_add_u32 s72, s72, 8192
    s_waitcnt lgkmcnt(4)
    buffer_store_dwordx4 v[48:51], v98, s[20:23], s72 offen sc1
    s_add_u32 s72, s72, 8192
    s_waitcnt lgkmcnt(2)
    buffer_store_dwordx4 v[52:55], v98, s[20:23], s72 offen sc1
    s_add_u32 s72, s72, 8192
    s_waitcnt lgkmcnt(0)
    buffer_store_dwordx4 v[56:59], v98, s[20:23], s72 offen sc1
    s_waitcnt vmcnt(9)
    v_lshlrev_b32 v88, 16, v28
    v_and_b32 v89, 0xffff0000, v28
    v_lshlrev_b32 v90, 16, v29
    v_and_b32 v91, 0xffff0000, v29
    v_lshlrev_b32 v92, 16, v30
    v_and_b32 v93, 0xffff0000, v30
    v_lshlrev_b32 v94, 16, v31
    v_and_b32 v95, 0xffff0000, v31
    v_dot2c_f32_bf16 v88, s48, v60
    v_dot2c_f32_bf16 v89, s49, v60
    v_dot2c_f32_bf16 v90, s48, v61
    v_dot2c_f32_bf16 v91, s49, v61
    v_dot2c_f32_bf16 v92, s48, v62
    v_dot2c_f32_bf16 v93, s49, v62
    v_dot2c_f32_bf16 v94, s48, v63
    v_dot2c_f32_bf16 v95, s49, v63
    v_dot2c_f32_bf16 v88, s48, v64
    v_dot2c_f32_bf16 v89, s49, v64
    v_dot2c_f32_bf16 v90, s48, v65
    v_dot2c_f32_bf16 v91, s49, v65
    v_dot2c_f32_bf16 v92, s48, v66
    v_dot2c_f32_bf16 v93, s49, v66
    v_dot2c_f32_bf16 v94, s48, v67
    v_dot2c_f32_bf16 v95, s49, v67
    v_dot2c_f32_bf16 v88, s48, v68
    v_dot2c_f32_bf16 v89, s49, v68
    v_dot2c_f32_bf16 v90, s48, v69
    v_dot2c_f32_bf16 v91, s49, v69
    v_dot2c_f32_bf16 v92, s48, v70
    v_dot2c_f32_bf16 v93, s49, v70
    v_dot2c_f32_bf16 v94, s48, v71
    v_dot2c_f32_bf16 v95, s49, v71
    v_dot2c_f32_bf16 v88, s48, v72
    v_dot2c_f32_bf16 v89, s49, v72
    v_dot2c_f32_bf16 v90, s48, v73
    v_dot2c_f32_bf16 v91, s49, v73
    v_dot2c_f32_bf16 v92, s48, v74
    v_dot2c_f32_bf16 v93, s49, v74
    v_dot2c_f32_bf16 v94, s48, v75
    v_dot2c_f32_bf16 v95, s49, v75
    v_dot2c_f32_bf16 v88, s48, v76
    v_dot2c_f32_bf16 v89, s49, v76
    v_dot2c_f32_bf16 v90, s48, v77
    v_dot2c_f32_bf16 v91, s49, v77
    v_dot2c_f32_bf16 v92, s48, v78
    v_dot2c_f32_bf16 v93, s49, v78
    v_dot2c_f32_bf16 v94, s48, v79
    v_dot2c_f32_bf16 v95, s49, v79
    v_dot2c_f32_bf16 v88, s48, v80
    v_dot2c_f32_bf16 v89, s49, v80
    v_dot2c_f32_bf16 v90, s48, v81
    v_dot2c_f32_bf16 v91, s49, v81
    v_dot2c_f32_bf16 v92, s48, v82
    v_dot2c_f32_bf16 v93, s49, v82
    v_dot2c_f32_bf16 v94, s48, v83
    v_dot2c_f32_bf16 v95, s49, v83
    v_dot2c_f32_bf16 v88, s48, v84
    v_dot2c_f32_bf16 v89, s49, v84
    v_dot2c_f32_bf16 v90, s48, v85
    v_dot2c_f32_bf16 v91, s49, v85
    v_dot2c_f32_bf16 v92, s48, v86
    v_dot2c_f32_bf16 v93, s49, v86
    v_dot2c_f32_bf16 v94, s48, v87
    v_dot2c_f32_bf16 v95, s49, v87
    v_permlane32_swap_b32 v88, v92
    v_permlane32_swap_b32 v89, v93
    v_permlane32_swap_b32 v90, v94
    v_permlane32_swap_b32 v91, v95
    v_add_f32 v88, v88, v92
    v_add_f32 v89, v89, v93
    v_add_f32 v90, v90, v94
    v_add_f32 v91, v91, v95
    s_nop 0
    v_permlane16_swap_b32 v88, v90
    v_permlane16_swap_b32 v89, v91
    v_add_f32 v88, v88, v90
    v_add_f32 v89, v89, v91
    ds_write_b64 v164, v[88:89] offset:61440
    s_waitcnt vmcnt(0) lgkmcnt(0)
    s_barrier
    s_cmp_lg_u32 s60, 2
    s_cbranch_scc1 Lfx_58
    v_mov_b32 v2, s67
    s_lshl_b32 s70, s61, 7
    s_add_u32 s70, s70, 15040512
    v_lshlrev_b32 v3, 2, v1
    s_mov_b32 exec_hi, 0
    buffer_store_dword v2, v3, s[20:23], s70 offen sc1
    s_mov_b32 exec_hi, -1
Lfx_58:
    s_cmp_ge_u32 s60, 2
    s_cbranch_scc1 Lcs_59
    v_lshlrev_b32 v96, 2, v0
    ds_read_b32 v4, v96 offset:61440
    ds_read_b32 v5, v96 offset:61952
    ds_read_b32 v6, v96 offset:62464
    ds_read_b32 v7, v96 offset:62976
    ds_read_b32 v8, v96 offset:63488
    ds_read_b32 v9, v96 offset:64000
    ds_read_b32 v10, v96 offset:64512
    ds_read_b32 v11, v96 offset:65024
    v_lshlrev_b32 v96, 4, v0
    s_add_u32 s70, s62, 14680064
    s_waitcnt lgkmcnt(0)
    v_add_f32 v4, v4, v5
    v_add_f32 v6, v6, v7
    v_add_f32 v8, v8, v9
    v_add_f32 v10, v10, v11
    v_add_f32 v4, v4, v6
    v_add_f32 v8, v8, v10
    v_add_f32 v4, v4, v8
    v_mov_b32 v5, s67
    buffer_store_dwordx2 v[4:5], v96, s[20:23], s70 offen sc1
Lcs_59:
    s_endpgm
L_exit:
    s_endpgm
.section .rodata,"a"
.p2align 6
.amdhsa_kernel parallel_sum__ssm_conv_s4d__glu_gated_reglu__prompt_kernel
  .amdhsa_next_free_vgpr 256
  .amdhsa_next_free_sgpr 102
  .amdhsa_accum_offset 256
  .amdhsa_group_segment_fixed_size 0
  .amdhsa_kernarg_size 112
  .amdhsa_user_sgpr_count 2
  .amdhsa_user_sgpr_kernarg_segment_ptr 1
  .amdhsa_system_sgpr_workgroup_id_x 1
.end_amdhsa_kernel
.text
```
